```python
import torch

def _softmax(x, axis=-1):
    return torch.softmax(x, dim=axis)
def _gelu(x):
    return torch.nn.functional.gelu(x, approximate="tanh")
def _silu(x):
    return torch.nn.functional.silu(x)
def _sigmoid(x):
    return torch.sigmoid(x)
def _layernorm(x, axis=-1, eps=1e-5):
    m = x.mean(dim=axis, keepdim=True)
    v = x.var(dim=axis, keepdim=True, unbiased=False)
    return (x - m) / torch.sqrt(v + eps)
def _scatter_add(tgt, idx, src, axis=0):
    return tgt.clone().index_add_(axis, idx, src)
def _segment_sum(src, seg, n):
    out = torch.zeros((n,) + src.shape[1:], dtype=src.dtype)
    return out.index_add_(0, seg, src)
def _pad(x, pw):
    flat = tuple(v for pair in reversed(pw) for v in pair)
    return torch.nn.functional.pad(x, flat)

kernel_name = 'standalone__dcn_v2_cross__recsys'

def setup_inputs():

    _w = (lambda a: (lambda t: t.to(torch.bfloat16) if t.is_floating_point() else t)(torch.as_tensor(a)))
    B, F, D, L = 1024, 100, 64, 3
    Din = min(F * D, 1024)
    return {
        "x0": _w((lambda *s: torch.randn(*s, dtype=torch.bfloat16) * 0.05)(B, Din)),
        "ws": _w((lambda *s: torch.randn(*s, dtype=torch.bfloat16) * 0.05)(L, Din, Din)),
        "bs": _w((lambda *s: torch.randn(*s, dtype=torch.bfloat16) * 0.05)(L, Din)),
    }

def reference(x0, ws, bs):
    x = x0
    for l in range(ws.shape[0]):
        x = x0 * (x @ ws[l] + bs[l]) + x
    return x
```

```asm
; @launch grid=(256,1,1) block=(256,1,1) lds=163840
.amdgcn_target "amdgcn-amd-amdhsa--gfx950"
.text
.globl standalone__dcn_v2_cross__recsys_kernel
.p2align 8
.type standalone__dcn_v2_cross__recsys_kernel,@function
standalone__dcn_v2_cross__recsys_kernel:
    s_cmp_ge_u32 s2, 256
    s_cbranch_scc1 L_end
    s_load_dwordx2 s[16:17], s[0:1], 0
    s_load_dwordx2 s[20:21], s[0:1], 8
    s_load_dwordx2 s[24:25], s[0:1], 16
    s_load_dwordx2 s[36:37], s[0:1], 40
    s_load_dwordx2 s[28:29], s[0:1], 24
    v_lshrrev_b32 v2, 6, v0
    v_and_b32 v1, 63, v0
    v_readfirstlane_b32 s40, v2
    s_and_b32 s51, s2, 6
    s_lshl_b32 s51, s51, 1
    s_lshr_b32 s49, s2, 6
    s_add_u32 s49, s49, s51
    s_and_b32 s51, s2, 1
    s_lshl_b32 s51, s51, 3
    s_bfe_u32 s50, s2, 0x30003
    s_add_u32 s50, s50, s51
    s_getpc_b64 s[8:9]
L_pc:
    s_and_b32 s10, s2, 0xf8
    s_lshl_b32 s11, s40, 1
    s_add_u32 s10, s10, s11
    s_lshl_b32 s10, s10, 6
    s_min_u32 s10, s10, L_end-L_pc
    v_mov_b32 v7, s10
    global_load_dword v30, v7, s[8:9]
    s_mov_b32 s22, 0x600000
    s_mov_b32 s23, 0x20000
    s_movk_i32 s42, 15360
    s_movk_i32 s43, 30720
    s_mov_b32 s44, 46080
    s_mul_i32 s41, s40, 40960
    s_add_u32 s34, s49, s50
    s_and_b32 s34, s34, 3
    s_lshr_b32 s96, s49, 3
    s_lshl_b32 s51, s49, 1
    s_add_u32 s96, s96, s51
    s_add_u32 s96, s96, s50
    s_and_b32 s96, s96, 3
    v_lshrrev_b32 v2, 3, v1
    v_lshlrev_b32 v2, 11, v2
    v_and_b32 v3, 7, v1
    v_lshrrev_b32 v4, 4, v1
    v_and_b32 v5, 1, v4
    v_lshlrev_b32 v6, 2, v5
    v_xor_b32 v6, v6, v3
    v_lshl_add_u32 v8, v6, 4, v2
    s_lshl_b32 s51, s40, 19
    s_lshl_b32 s52, s50, 7
    s_add_u32 s51, s51, s52
    s_lshl_b32 s52, s96, 17
    s_add_u32 s51, s51, s52
    v_add_u32 v8, s51, v8
    s_waitcnt lgkmcnt(0)
    v_add_u32 v26, 0x200000, v8
    s_add_u32 m0, s41, 0
    s_nop 0
    buffer_load_dwordx4 v8, s[20:23], 0 offen offset:0  lds
    buffer_load_dwordx4 v8, s[20:23], s42 offen offset:1024  lds
    buffer_load_dwordx4 v8, s[20:23], s43 offen offset:2048  lds
    buffer_load_dwordx4 v8, s[20:23], s44 offen offset:3072  lds
    s_lshr_b32 s97, s50, 2
    s_and_b32 s97, s97, 2
    s_xor_b32 s97, s97, s40
    v_xor_b32 v6, v3, v4
    v_lshl_add_u32 v9, v6, 4, v2
    s_lshr_b32 s53, s97, 1
    s_lshl_b32 s54, s49, 1
    s_add_u32 s54, s54, s53
    s_lshl_b32 s54, s54, 16
    s_xor_b32 s32, s54, 0x10000
    s_lshl_b32 s51, s40, 9
    s_add_u32 s51, s51, s32
    s_lshl_b32 s52, s96, 7
    s_add_u32 s51, s51, s52
    v_add_u32 v9, s51, v9
    v_xor_b32 v10, 64, v9
    s_mov_b32 s18, 0x200000
    s_mov_b32 s19, 0x20000
    s_add_u32 m0, s41, 4096
    s_nop 0
    buffer_load_dwordx4 v9, s[16:19], 0 offen offset:0  lds
    buffer_load_dwordx4 v10, s[16:19], s42 offen offset:1024  lds
    buffer_load_dwordx4 v9, s[16:19], s43 offen offset:2048  lds
    buffer_load_dwordx4 v10, s[16:19], s44 offen offset:3072  lds
    s_add_u32 m0, s41, 8192
    v_xor_b32 v8, 0x10000, v8
    buffer_load_dwordx4 v8, s[20:23], 0 offen offset:0  lds
    buffer_load_dwordx4 v8, s[20:23], s42 offen offset:1024  lds
    buffer_load_dwordx4 v8, s[20:23], s43 offen offset:2048  lds
    buffer_load_dwordx4 v8, s[20:23], s44 offen offset:3072  lds
    s_mov_b32 s26, 0x1800
    s_mov_b32 s27, 0x20000
    s_mov_b32 s38, 0x800000
    s_mov_b32 s39, 0x20000
    s_mov_b32 s30, 0x200000
    s_mov_b32 s31, 0x20000
    s_movk_i32 s45, 4096
    v_lshrrev_b32 v2, 4, v1
    s_and_b32 s33, s40, 1
    s_lshl_b32 s51, s50, 1
    s_add_u32 s51, s51, s33
    s_lshl_b32 s52, s51, 6
    v_lshlrev_b32 v25, 4, v2
    v_add_u32 v25, s52, v25
    s_lshr_b32 s51, s2, 3
    s_lshl_b32 s51, s51, 2
    s_add_u32 s51, s51, s40
    s_lshl_b32 s51, s51, 14
    s_and_b32 s52, s50, 8
    s_or_b32 s52, s52, 3
    s_lshl_b32 s52, s52, 7
    s_add_u32 s51, s51, s52
    v_lshlrev_b32 v6, 11, v1
    v_add_u32 v6, s51, v6
    v_mov_b32 v7, 0x7ffffff0
    v_cmp_gt_u32 vcc, 8, v1
    s_mov_b32 s48, 0x200000
    s_mov_b32 s46, 0x400000
    v_cndmask_b32 v27, v7, v6, vcc
    s_lshl_b32 s51, s49, 8
    s_add_u32 s51, s51, 0x4a0000
    buffer_load_dword v30, v27, s[20:23], 0 offen
    s_lshr_b32 s52, s2, 3
    s_lshl_b32 s52, s52, 2
    s_add_u32 s52, s52, s40
    s_lshl_b32 s52, s52, 12
    s_and_b32 s53, s49, 12
    s_lshl_b32 s53, s53, 17
    s_add_u32 s52, s52, s53
    s_add_u32 s52, s52, 384
    v_lshlrev_b32 v6, 10, v1
    v_add_u32 v6, s52, v6
    v_cmp_gt_u32 vcc, 4, v1
    s_nop 1
    v_cndmask_b32 v6, v7, v6, vcc
    buffer_load_dword v30, v6, s[16:19], 0 offen
    v_mov_b32 v6, s51
    buffer_load_dwordx2 v[120:121], v6, s[36:39], 0 offen sc1
    s_and_b32 s52, s2, 6
    s_lshl_b32 s52, s52, 18
    s_and_b32 s53, s2, 0xf8
    s_lshl_b32 s53, s53, 11
    s_add_u32 s52, s52, s53
    s_lshl_b32 s53, s40, 12
    s_add_u32 s52, s52, s53
    s_and_b32 s53, s2, 1
    s_lshl_b32 s53, s53, 10
    s_add_u32 s52, s52, s53
    v_lshrrev_b32 v6, 3, v1
    v_lshlrev_b32 v6, 11, v6
    v_and_b32 v31, 7, v1
    v_lshl_add_u32 v31, v31, 7, v6
    v_add_u32 v31, s52, v31
    v_cmp_gt_u32 vcc, 16, v1
    v_mov_b32 v7, 0x7ffffff0
    s_nop 0
    v_cndmask_b32 v31, v7, v31, vcc
    buffer_load_dwordx4 v[96:99], v25, s[24:27], 0 offen offset:0
    buffer_load_dwordx4 v[104:107], v25, s[24:27], 0 offen offset:2048
    buffer_load_dwordx4 v[112:115], v25, s[24:27], s45 offen offset:0
    s_mov_b32 s59, s2
    s_mov_b32 s57, 0
    v_and_b32 v3, 15, v1
    s_lshl_b32 s51, s50, 1
    s_add_u32 s51, s51, s33
    s_lshl_b32 s52, s51, 6
    v_lshl_add_u32 v24, v3, 11, v25
    v_add_u32 v24, s54, v24
    s_mov_b32 s58, 0x8000
    v_lshrrev_b32 v5, 2, v1
    v_and_b32 v6, 3, v1
    v_lshlrev_b32 v6, 4, v6
    v_lshl_add_u32 v28, v5, 11, v6
    s_add_u32 s52, s52, s54
    v_add_u32 v28, s52, v28
    s_movk_i32 s47, 31744
    v_lshlrev_b32 v6, 4, v2
    v_lshl_add_u32 v29, v3, 6, v6
    v_add_u32 v29, s41, v29
    s_xor_b32 s98, s96, 0
    s_lshl_b32 s98, s98, 12
    s_xor_b32 s99, s96, 1
    s_lshl_b32 s99, s99, 12
    s_xor_b32 s100, s96, 2
    s_lshl_b32 s100, s100, 12
    s_xor_b32 s101, s96, 3
    s_lshl_b32 s101, s101, 12
    v_lshlrev_b32 v4, 4, v1
    s_lshl_b32 s52, s51, 11
    s_add_u32 s52, s52, s54
    v_add_u32 v23, s52, v4
    s_lshl_b32 s52, s40, 14
    s_add_u32 s52, s52, s32
    v_add_u32 v17, s52, v4
    v_xor_b32 v18, 0x10000, v17
    s_mov_b32 s56, 0x200000
    v_add_u32 v22, s41, v4
    s_xor_b32 s52, s40, 2
    s_mul_i32 s52, s52, 40960
    s_add_u32 s52, s52, 32768
    v_add_u32 v19, s52, v4
    s_xor_b32 s52, s40, 3
    s_mul_i32 s52, s52, 40960
    s_add_u32 s52, s52, 36864
    v_add_u32 v20, s52, v4
    s_xor_b32 s52, s40, 1
    s_mul_i32 s52, s52, 40960
    s_add_u32 s52, s52, 28672
    v_add_u32 v21, s52, v4
    v_bfe_u32 v5, v3, 1, 3
    v_xor_b32 v5, v5, v2
    v_lshlrev_b32 v5, 4, v5
    v_lshl_add_u32 v5, v3, 7, v5
    v_add_u32 v13, s41, v5
    v_xor_b32 v14, 64, v13
    v_bfe_u32 v3, v1, 2, 2
    v_lshl_add_u32 v5, v2, 3, v3
    v_lshlrev_b32 v5, 7, v5
    v_and_b32 v6, 3, v1
    v_bfe_u32 v7, v1, 3, 1
    v_xor_b32 v7, s33, v7
    v_lshl_add_u32 v6, v7, 2, v6
    v_lshl_add_u32 v5, v6, 4, v5
    v_add_u32 v11, s41, v5
    v_xor_b32 v12, 64, v11
    s_lshl_b32 s51, s49, 4
    s_add_u32 s52, s51, s50
    s_lshl_b32 s52, s52, 2
    s_add_u32 s52, s52, s40
    s_lshl_b32 s52, s52, 7
    s_add_u32 s52, s52, 0x400000
    s_add_u32 s2, s36, s52
    s_addc_u32 s3, s37, 0
    s_lshl_b32 s52, s40, 2
    s_add_u32 s51, s51, s52
    s_lshl_b32 s51, s51, 2
    s_lshr_b32 s52, s50, 2
    s_add_u32 s51, s51, s52
    s_lshl_b32 s51, s51, 7
    s_and_b32 s52, s50, 3
    s_lshl_b32 s52, s52, 3
    s_add_u32 s51, s51, s52
    s_add_u32 s51, s51, 0x400000
    s_add_u32 s6, s36, s51
    s_addc_u32 s7, s37, 0
    s_waitcnt vmcnt(14)
    s_add_u32 m0, s41, 12288
    v_xor_b32 v8, 0x30000, v8
    buffer_load_dwordx4 v8, s[20:23], 0 offen offset:0  lds
    buffer_load_dwordx4 v8, s[20:23], s42 offen offset:1024  lds
    buffer_load_dwordx4 v8, s[20:23], s43 offen offset:2048  lds
    buffer_load_dwordx4 v8, s[20:23], s44 offen offset:3072  lds
    ds_read_b64_tr_b16 a[0:1], v11 offset:0
    ds_read_b64_tr_b16 a[2:3], v11 offset:512
    ds_read_b64_tr_b16 a[4:5], v11 offset:8
    ds_read_b64_tr_b16 a[6:7], v11 offset:520
    ds_read_b64_tr_b16 a[8:9], v12 offset:0
    ds_read_b64_tr_b16 a[10:11], v12 offset:512
    ds_read_b64_tr_b16 a[12:13], v12 offset:8
    ds_read_b64_tr_b16 a[14:15], v12 offset:520
    s_waitcnt vmcnt(14)
    s_add_u32 m0, s41, 16384
    v_xor_b32 v8, 0x10000, v8
    buffer_load_dwordx4 v8, s[20:23], 0 offen offset:0  lds
    buffer_load_dwordx4 v8, s[20:23], s42 offen offset:1024  lds
    buffer_load_dwordx4 v8, s[20:23], s43 offen offset:2048  lds
    buffer_load_dwordx4 v8, s[20:23], s44 offen offset:3072  lds
    ds_read_b128 v[128:131], v13 offset:4096
    ds_read_b128 v[132:135], v13 offset:6144
    ds_read_b128 v[136:139], v14 offset:4096
    ds_read_b128 v[140:143], v14 offset:6144
    s_waitcnt vmcnt(14)
    s_add_u32 m0, s41, 20480
    v_xor_b32 v9, 0x80, v9
    v_xor_b32 v10, 0x80, v10
    buffer_load_dwordx4 v9, s[16:19], 0 offen offset:0  lds
    buffer_load_dwordx4 v10, s[16:19], s42 offen offset:1024  lds
    buffer_load_dwordx4 v9, s[16:19], s43 offen offset:2048  lds
    buffer_load_dwordx4 v10, s[16:19], s44 offen offset:3072  lds
    ds_read_b64_tr_b16 a[16:17], v11 offset:8192
    ds_read_b64_tr_b16 a[18:19], v11 offset:8704
    ds_read_b64_tr_b16 a[20:21], v11 offset:8200
    ds_read_b64_tr_b16 a[22:23], v11 offset:8712
    ds_read_b64_tr_b16 a[24:25], v12 offset:8192
    ds_read_b64_tr_b16 a[26:27], v12 offset:8704
    ds_read_b64_tr_b16 a[28:29], v12 offset:8200
    ds_read_b64_tr_b16 a[30:31], v12 offset:8712
    s_waitcnt lgkmcnt(0)
    v_mfma_f32_16x16x32_bf16 a[144:147], a[8:11], v[128:131], 0
    v_mfma_f32_16x16x32_bf16 a[148:151], a[12:15], v[128:131], 0
    v_mfma_f32_16x16x32_bf16 a[128:131], a[0:3], v[128:131], 0
    v_mfma_f32_16x16x32_bf16 a[132:135], a[4:7], v[128:131], 0
    v_mfma_f32_16x16x32_bf16 a[152:155], a[8:11], v[132:135], 0
    v_mfma_f32_16x16x32_bf16 a[156:159], a[12:15], v[132:135], 0
    v_mfma_f32_16x16x32_bf16 a[136:139], a[0:3], v[132:135], 0
    v_mfma_f32_16x16x32_bf16 a[140:143], a[4:7], v[132:135], 0
    s_waitcnt vmcnt(8)
    s_add_u32 m0, s41, 24576
    v_xor_b32 v9, 0x180, v9
    v_xor_b32 v10, 0x180, v10
    buffer_load_dwordx4 v9, s[16:19], 0 offen offset:0  lds
    buffer_load_dwordx4 v10, s[16:19], s42 offen offset:1024  lds
    buffer_load_dwordx4 v9, s[16:19], s43 offen offset:2048  lds
    buffer_load_dwordx4 v10, s[16:19], s44 offen offset:3072  lds
    ds_read_b64_tr_b16 a[32:33], v11 offset:12288
    ds_read_b64_tr_b16 a[34:35], v11 offset:12800
    ds_read_b64_tr_b16 a[36:37], v11 offset:12296
    ds_read_b64_tr_b16 a[38:39], v11 offset:12808
    ds_read_b64_tr_b16 a[40:41], v12 offset:12288
    ds_read_b64_tr_b16 a[42:43], v12 offset:12800
    ds_read_b64_tr_b16 a[44:45], v12 offset:12296
    ds_read_b64_tr_b16 a[46:47], v12 offset:12808
    v_mfma_f32_16x16x32_bf16 a[144:147], a[24:27], v[136:139], a[144:147]
    v_mfma_f32_16x16x32_bf16 a[148:151], a[28:31], v[136:139], a[148:151]
    v_mfma_f32_16x16x32_bf16 a[128:131], a[16:19], v[136:139], a[128:131]
    v_mfma_f32_16x16x32_bf16 a[132:135], a[20:23], v[136:139], a[132:135]
    v_mfma_f32_16x16x32_bf16 a[152:155], a[24:27], v[140:143], a[152:155]
    v_mfma_f32_16x16x32_bf16 a[156:159], a[28:31], v[140:143], a[156:159]
    v_mfma_f32_16x16x32_bf16 a[136:139], a[16:19], v[140:143], a[136:139]
    v_mfma_f32_16x16x32_bf16 a[140:143], a[20:23], v[140:143], a[140:143]
    s_waitcnt vmcnt(8)
    s_add_u32 m0, s41, 28672
    v_xor_b32 v9, 0x80, v9
    v_xor_b32 v10, 0x80, v10
    buffer_load_dwordx4 v9, s[16:19], 0 offen offset:0  lds
    buffer_load_dwordx4 v10, s[16:19], s42 offen offset:1024  lds
    buffer_load_dwordx4 v9, s[16:19], s43 offen offset:2048  lds
    buffer_load_dwordx4 v10, s[16:19], s44 offen offset:3072  lds
    ds_read_b64_tr_b16 a[48:49], v11 offset:16384
    ds_read_b64_tr_b16 a[50:51], v11 offset:16896
    ds_read_b64_tr_b16 a[52:53], v11 offset:16392
    ds_read_b64_tr_b16 a[54:55], v11 offset:16904
    ds_read_b64_tr_b16 a[56:57], v12 offset:16384
    ds_read_b64_tr_b16 a[58:59], v12 offset:16896
    ds_read_b64_tr_b16 a[60:61], v12 offset:16392
    ds_read_b64_tr_b16 a[62:63], v12 offset:16904
    s_waitcnt vmcnt(8)
    s_add_u32 m0, s41, 32768
    v_xor_b32 v8, 0x70000, v8
    buffer_load_dwordx4 v8, s[20:23], 0 offen offset:0  lds
    buffer_load_dwordx4 v8, s[20:23], s42 offen offset:1024  lds
    buffer_load_dwordx4 v8, s[20:23], s43 offen offset:2048  lds
    buffer_load_dwordx4 v8, s[20:23], s44 offen offset:3072  lds
    ds_read_b128 v[144:147], v13 offset:20480
    ds_read_b128 v[148:151], v13 offset:22528
    ds_read_b128 v[152:155], v14 offset:20480
    ds_read_b128 v[156:159], v14 offset:22528
    s_waitcnt lgkmcnt(0)
    v_mfma_f32_16x16x32_bf16 a[144:147], a[40:43], v[144:147], a[144:147]
    v_lshlrev_b32 v80, 16, v96
    v_and_b32 v81, 0xffff0000, v96
    v_mfma_f32_16x16x32_bf16 a[148:151], a[44:47], v[144:147], a[148:151]
    v_lshlrev_b32 v82, 16, v97
    v_and_b32 v83, 0xffff0000, v97
    v_mfma_f32_16x16x32_bf16 a[128:131], a[32:35], v[144:147], a[128:131]
    v_lshlrev_b32 v84, 16, v98
    v_and_b32 v85, 0xffff0000, v98
    v_mfma_f32_16x16x32_bf16 a[132:135], a[36:39], v[144:147], a[132:135]
    v_lshlrev_b32 v86, 16, v99
    v_and_b32 v87, 0xffff0000, v99
    v_mfma_f32_16x16x32_bf16 a[152:155], a[40:43], v[148:151], a[152:155]
    v_mfma_f32_16x16x32_bf16 a[156:159], a[44:47], v[148:151], a[156:159]
    v_mfma_f32_16x16x32_bf16 a[136:139], a[32:35], v[148:151], a[136:139]
    v_mfma_f32_16x16x32_bf16 a[140:143], a[36:39], v[148:151], a[140:143]
    s_waitcnt vmcnt(8)
    s_add_u32 m0, s41, 36864
    s_nop 0
    buffer_load_dwordx4 v28, s[16:19], 0 offen lds
    buffer_load_dwordx4 v28, s[16:19], s47 offen offset:1024 lds
    ds_read_b128 v[160:163], v13 offset:24576
    ds_read_b128 v[164:167], v13 offset:26624
    ds_read_b128 v[168:171], v14 offset:24576
    ds_read_b128 v[172:175], v14 offset:26624
    v_readfirstlane_b32 s4, v120
    v_readfirstlane_b32 s5, v121
    v_mfma_f32_16x16x32_bf16 a[144:147], a[56:59], v[152:155], a[144:147]
    v_mfma_f32_16x16x32_bf16 a[148:151], a[60:63], v[152:155], a[148:151]
    v_mfma_f32_16x16x32_bf16 a[128:131], a[48:51], v[152:155], a[128:131]
    v_mfma_f32_16x16x32_bf16 a[132:135], a[52:55], v[152:155], a[132:135]
    v_mfma_f32_16x16x32_bf16 a[152:155], a[56:59], v[156:159], a[152:155]
    v_mfma_f32_16x16x32_bf16 a[156:159], a[60:63], v[156:159], a[156:159]
    v_mfma_f32_16x16x32_bf16 a[136:139], a[48:51], v[156:159], a[136:139]
    v_mfma_f32_16x16x32_bf16 a[140:143], a[52:55], v[156:159], a[140:143]
    s_waitcnt vmcnt(6)
    s_add_u32 m0, s41, 0
    v_xor_b32 v8, 0x10000, v8
    buffer_load_dwordx4 v8, s[20:23], 0 offen offset:0  lds
    buffer_load_dwordx4 v8, s[20:23], s42 offen offset:1024  lds
    buffer_load_dwordx4 v8, s[20:23], s43 offen offset:2048  lds
    buffer_load_dwordx4 v8, s[20:23], s44 offen offset:3072  lds
    ds_read_b128 v[176:179], v13 offset:28672
    ds_read_b128 v[180:183], v13 offset:30720
    ds_read_b128 v[184:187], v14 offset:28672
    ds_read_b128 v[188:191], v14 offset:30720
    s_waitcnt vmcnt(6)
    s_add_u32 m0, s41, 4096
    v_xor_b32 v8, 0x30000, v8
    buffer_load_dwordx4 v8, s[20:23], 0 offen offset:0  lds
    buffer_load_dwordx4 v8, s[20:23], s42 offen offset:1024  lds
    buffer_load_dwordx4 v8, s[20:23], s43 offen offset:2048  lds
    buffer_load_dwordx4 v8, s[20:23], s44 offen offset:3072  lds
    ds_read_b64_tr_b16 a[64:65], v11 offset:32768
    ds_read_b64_tr_b16 a[66:67], v11 offset:33280
    ds_read_b64_tr_b16 a[68:69], v11 offset:32776
    ds_read_b64_tr_b16 a[70:71], v11 offset:33288
    ds_read_b64_tr_b16 a[72:73], v12 offset:32768
    ds_read_b64_tr_b16 a[74:75], v12 offset:33280
    ds_read_b64_tr_b16 a[76:77], v12 offset:32776
    ds_read_b64_tr_b16 a[78:79], v12 offset:33288
    s_waitcnt vmcnt(8)
    s_add_u32 m0, s41, 8192
    v_xor_b32 v8, 0x10000, v8
    buffer_load_dwordx4 v8, s[20:23], 0 offen offset:0  lds
    buffer_load_dwordx4 v8, s[20:23], s42 offen offset:1024  lds
    buffer_load_dwordx4 v8, s[20:23], s43 offen offset:2048  lds
    buffer_load_dwordx4 v8, s[20:23], s44 offen offset:3072  lds
    ds_read_b128 v[120:123], v29 offset:36864
    ds_read_b128 v[124:127], v29 offset:37888
    s_waitcnt vmcnt(8)
    s_add_u32 m0, s41, 12288
    v_xor_b32 v9, 0x10180, v9
    v_xor_b32 v10, 0x10180, v10
    buffer_load_dwordx4 v9, s[16:19], 0 offen offset:0  lds
    buffer_load_dwordx4 v10, s[16:19], s42 offen offset:1024  lds
    buffer_load_dwordx4 v9, s[16:19], s43 offen offset:2048  lds
    buffer_load_dwordx4 v10, s[16:19], s44 offen offset:3072  lds
    ds_read_b64_tr_b16 a[80:81], v11 offset:0
    ds_read_b64_tr_b16 a[82:83], v11 offset:512
    ds_read_b64_tr_b16 a[84:85], v11 offset:8
    ds_read_b64_tr_b16 a[86:87], v11 offset:520
    ds_read_b64_tr_b16 a[88:89], v12 offset:0
    ds_read_b64_tr_b16 a[90:91], v12 offset:512
    ds_read_b64_tr_b16 a[92:93], v12 offset:8
    ds_read_b64_tr_b16 a[94:95], v12 offset:520
    s_waitcnt lgkmcnt(0)
    s_barrier
    s_add_u32 s4, s4, 1
    s_addc_u32 s5, s5, 0
    v_mfma_f32_16x16x32_bf16 a[144:147], a[72:75], v[160:163], a[144:147]
    v_mfma_f32_16x16x32_bf16 a[148:151], a[76:79], v[160:163], a[148:151]
    v_mfma_f32_16x16x32_bf16 a[128:131], a[64:67], v[160:163], a[128:131]
    v_mfma_f32_16x16x32_bf16 a[132:135], a[68:71], v[160:163], a[132:135]
    v_mfma_f32_16x16x32_bf16 a[152:155], a[72:75], v[164:167], a[152:155]
    v_mfma_f32_16x16x32_bf16 a[156:159], a[76:79], v[164:167], a[156:159]
    v_mfma_f32_16x16x32_bf16 a[136:139], a[64:67], v[164:167], a[136:139]
    v_mfma_f32_16x16x32_bf16 a[140:143], a[68:71], v[164:167], a[140:143]
    s_waitcnt vmcnt(8)
    s_add_u32 m0, s41, 16384
    v_xor_b32 v9, 0x80, v9
    v_xor_b32 v10, 0x80, v10
    buffer_load_dwordx4 v9, s[16:19], 0 offen offset:0  lds
    buffer_load_dwordx4 v10, s[16:19], s42 offen offset:1024  lds
    buffer_load_dwordx4 v9, s[16:19], s43 offen offset:2048  lds
    buffer_load_dwordx4 v10, s[16:19], s44 offen offset:3072  lds
    ds_read_b64_tr_b16 a[96:97], v11 offset:4096
    ds_read_b64_tr_b16 a[98:99], v11 offset:4608
    ds_read_b64_tr_b16 a[100:101], v11 offset:4104
    ds_read_b64_tr_b16 a[102:103], v11 offset:4616
    ds_read_b64_tr_b16 a[104:105], v12 offset:4096
    ds_read_b64_tr_b16 a[106:107], v12 offset:4608
    ds_read_b64_tr_b16 a[108:109], v12 offset:4104
    ds_read_b64_tr_b16 a[110:111], v12 offset:4616
    v_mfma_f32_16x16x32_bf16 a[144:147], a[88:91], v[168:171], a[144:147]
    v_mfma_f32_16x16x32_bf16 a[148:151], a[92:95], v[168:171], a[148:151]
    v_mfma_f32_16x16x32_bf16 a[128:131], a[80:83], v[168:171], a[128:131]
    v_mfma_f32_16x16x32_bf16 a[132:135], a[84:87], v[168:171], a[132:135]
    v_mfma_f32_16x16x32_bf16 a[152:155], a[88:91], v[172:175], a[152:155]
    v_mfma_f32_16x16x32_bf16 a[156:159], a[92:95], v[172:175], a[156:159]
    v_mfma_f32_16x16x32_bf16 a[136:139], a[80:83], v[172:175], a[136:139]
    v_mfma_f32_16x16x32_bf16 a[140:143], a[84:87], v[172:175], a[140:143]
    s_waitcnt vmcnt(8)
    s_add_u32 m0, s41, 20480
    v_xor_b32 v9, 0x180, v9
    v_xor_b32 v10, 0x180, v10
    buffer_load_dwordx4 v9, s[16:19], 0 offen offset:0  lds
    buffer_load_dwordx4 v10, s[16:19], s42 offen offset:1024  lds
    buffer_load_dwordx4 v9, s[16:19], s43 offen offset:2048  lds
    buffer_load_dwordx4 v10, s[16:19], s44 offen offset:3072  lds
    ds_read_b64_tr_b16 a[112:113], v11 offset:8192
    ds_read_b64_tr_b16 a[114:115], v11 offset:8704
    ds_read_b64_tr_b16 a[116:117], v11 offset:8200
    ds_read_b64_tr_b16 a[118:119], v11 offset:8712
    ds_read_b64_tr_b16 a[120:121], v12 offset:8192
    ds_read_b64_tr_b16 a[122:123], v12 offset:8704
    ds_read_b64_tr_b16 a[124:125], v12 offset:8200
    ds_read_b64_tr_b16 a[126:127], v12 offset:8712
    s_waitcnt lgkmcnt(0)
    v_mfma_f32_16x16x32_bf16 a[144:147], a[104:107], v[176:179], a[144:147]
    v_lshlrev_b32 v48, 16, v120
    v_and_b32 v49, 0xffff0000, v120
    v_mfma_f32_16x16x32_bf16 a[148:151], a[108:111], v[176:179], a[148:151]
    v_lshlrev_b32 v50, 16, v121
    v_and_b32 v51, 0xffff0000, v121
    v_mfma_f32_16x16x32_bf16 a[128:131], a[96:99], v[176:179], a[128:131]
    v_lshlrev_b32 v52, 16, v122
    v_and_b32 v53, 0xffff0000, v122
    v_mfma_f32_16x16x32_bf16 a[132:135], a[100:103], v[176:179], a[132:135]
    v_lshlrev_b32 v54, 16, v123
    v_and_b32 v55, 0xffff0000, v123
    v_mfma_f32_16x16x32_bf16 a[152:155], a[104:107], v[180:183], a[152:155]
    v_lshlrev_b32 v56, 16, v124
    v_and_b32 v57, 0xffff0000, v124
    v_mfma_f32_16x16x32_bf16 a[156:159], a[108:111], v[180:183], a[156:159]
    v_lshlrev_b32 v58, 16, v125
    v_and_b32 v59, 0xffff0000, v125
    v_mfma_f32_16x16x32_bf16 a[136:139], a[96:99], v[180:183], a[136:139]
    v_lshlrev_b32 v60, 16, v126
    v_and_b32 v61, 0xffff0000, v126
    v_mfma_f32_16x16x32_bf16 a[140:143], a[100:103], v[180:183], a[140:143]
    v_lshlrev_b32 v62, 16, v127
    v_and_b32 v63, 0xffff0000, v127
    s_waitcnt vmcnt(8)
    s_add_u32 m0, s41, 24576
    v_xor_b32 v9, 0x80, v9
    v_xor_b32 v10, 0x80, v10
    buffer_load_dwordx4 v9, s[16:19], 0 offen offset:0  lds
    buffer_load_dwordx4 v10, s[16:19], s42 offen offset:1024  lds
    buffer_load_dwordx4 v9, s[16:19], s43 offen offset:2048  lds
    buffer_load_dwordx4 v10, s[16:19], s44 offen offset:3072  lds
    ds_read_b128 v[192:195], v13 offset:12288
    ds_read_b128 v[196:199], v13 offset:14336
    ds_read_b128 v[200:203], v14 offset:12288
    ds_read_b128 v[204:207], v14 offset:14336
    v_mfma_f32_16x16x32_bf16 a[144:147], a[120:123], v[184:187], a[144:147]
    v_mov_b32 v64, v48
    v_mov_b32 v65, v49
    v_mfma_f32_16x16x32_bf16 a[148:151], a[124:127], v[184:187], a[148:151]
    v_mov_b32 v66, v50
    v_mov_b32 v67, v51
    v_mfma_f32_16x16x32_bf16 a[128:131], a[112:115], v[184:187], a[128:131]
    v_mov_b32 v68, v52
    v_mov_b32 v69, v53
    v_mfma_f32_16x16x32_bf16 a[132:135], a[116:119], v[184:187], a[132:135]
    v_mov_b32 v70, v54
    v_mov_b32 v71, v55
    v_mfma_f32_16x16x32_bf16 a[152:155], a[120:123], v[188:191], a[152:155]
    v_mov_b32 v72, v56
    v_mov_b32 v73, v57
    v_mfma_f32_16x16x32_bf16 a[156:159], a[124:127], v[188:191], a[156:159]
    v_mov_b32 v74, v58
    v_mov_b32 v75, v59
    v_mfma_f32_16x16x32_bf16 a[136:139], a[112:115], v[188:191], a[136:139]
    v_mov_b32 v76, v60
    v_mov_b32 v77, v61
    v_mfma_f32_16x16x32_bf16 a[140:143], a[116:119], v[188:191], a[140:143]
    v_mov_b32 v78, v62
    v_mov_b32 v79, v63
    s_waitcnt lgkmcnt(0)
    v_mfma_f32_16x16x32_bf16 a[160:163], a[8:11], v[192:195], 0
    v_mfma_f32_16x16x32_bf16 a[164:167], a[12:15], v[192:195], 0
    v_mfma_f32_16x16x32_bf16 a[168:171], a[8:11], v[196:199], 0
    v_mfma_f32_16x16x32_bf16 a[172:175], a[12:15], v[196:199], 0
    ds_write_b128 v20, a[144:147] offset:0
    s_waitcnt vmcnt(8)
    s_add_u32 m0, s41, 0
    s_nop 0
    buffer_load_dwordx4 v26, s[20:23], 0 offen offset:0  lds
    buffer_load_dwordx4 v26, s[20:23], s42 offen offset:1024  lds
    buffer_load_dwordx4 v26, s[20:23], s43 offen offset:2048  lds
    buffer_load_dwordx4 v26, s[20:23], s44 offen offset:3072  lds
    buffer_load_dword v30, v31, s[20:23], s46 offen
    buffer_load_dword v30, v27, s[20:23], s48 offen
    ds_read_b128 v[208:211], v13 offset:16384
    ds_read_b128 v[212:215], v13 offset:18432
    ds_read_b128 v[216:219], v14 offset:16384
    ds_read_b128 v[220:223], v14 offset:18432
    v_mfma_f32_16x16x32_bf16 a[160:163], a[24:27], v[200:203], a[160:163]
    v_mfma_f32_16x16x32_bf16 a[164:167], a[28:31], v[200:203], a[164:167]
    v_mfma_f32_16x16x32_bf16 a[168:171], a[24:27], v[204:207], a[168:171]
    v_mfma_f32_16x16x32_bf16 a[172:175], a[28:31], v[204:207], a[172:175]
    ds_write_b128 v20, a[148:151] offset:1024
    s_waitcnt lgkmcnt(1)
    v_mfma_f32_16x16x32_bf16 a[160:163], a[40:43], v[208:211], a[160:163]
    v_mfma_f32_16x16x32_bf16 a[164:167], a[44:47], v[208:211], a[164:167]
    v_mfma_f32_16x16x32_bf16 v[32:35], a[0:3], v[192:195], v[80:83]
    v_mfma_f32_16x16x32_bf16 v[36:39], a[4:7], v[192:195], v[84:87]
    ds_write_b128 v20, a[152:155] offset:2048
    v_mfma_f32_16x16x32_bf16 a[168:171], a[40:43], v[212:215], a[168:171]
    v_mfma_f32_16x16x32_bf16 a[172:175], a[44:47], v[212:215], a[172:175]
    v_mfma_f32_16x16x32_bf16 v[40:43], a[0:3], v[196:199], v[80:83]
    v_mfma_f32_16x16x32_bf16 v[44:47], a[4:7], v[196:199], v[84:87]
    ds_write_b128 v20, a[156:159] offset:3072
    s_waitcnt vmcnt(10)
    s_add_u32 m0, s41, 4096
    v_xor_b32 v26, 0x10000, v26
    buffer_load_dwordx4 v26, s[20:23], 0 offen offset:0  lds
    buffer_load_dwordx4 v26, s[20:23], s42 offen offset:1024  lds
    buffer_load_dwordx4 v26, s[20:23], s43 offen offset:2048  lds
    buffer_load_dwordx4 v26, s[20:23], s44 offen offset:3072  lds
    ds_read_b128 v[224:227], v13 offset:20480
    ds_read_b128 v[228:231], v13 offset:22528
    ds_read_b128 v[232:235], v14 offset:20480
    ds_read_b128 v[236:239], v14 offset:22528
    v_mfma_f32_16x16x32_bf16 a[160:163], a[56:59], v[216:219], a[160:163]
    v_mfma_f32_16x16x32_bf16 a[164:167], a[60:63], v[216:219], a[164:167]
    v_mfma_f32_16x16x32_bf16 v[32:35], a[16:19], v[200:203], v[32:35]
    v_mfma_f32_16x16x32_bf16 v[36:39], a[20:23], v[200:203], v[36:39]
    ds_write_b128 v19, a[128:131] offset:0
    v_mfma_f32_16x16x32_bf16 a[168:171], a[56:59], v[220:223], a[168:171]
    v_mfma_f32_16x16x32_bf16 a[172:175], a[60:63], v[220:223], a[172:175]
    v_mfma_f32_16x16x32_bf16 v[40:43], a[16:19], v[204:207], v[40:43]
    v_mfma_f32_16x16x32_bf16 v[44:47], a[20:23], v[204:207], v[44:47]
    ds_write_b128 v19, a[132:135] offset:1024
    s_waitcnt lgkmcnt(2)
    v_mfma_f32_16x16x32_bf16 a[160:163], a[72:75], v[224:227], a[160:163]
    v_mfma_f32_16x16x32_bf16 a[164:167], a[76:79], v[224:227], a[164:167]
    v_mfma_f32_16x16x32_bf16 v[32:35], a[32:35], v[208:211], v[32:35]
    v_mfma_f32_16x16x32_bf16 v[36:39], a[36:39], v[208:211], v[36:39]
    ds_write_b128 v19, a[136:139] offset:2048
    v_mfma_f32_16x16x32_bf16 a[168:171], a[72:75], v[228:231], a[168:171]
    v_mfma_f32_16x16x32_bf16 a[172:175], a[76:79], v[228:231], a[172:175]
    v_mfma_f32_16x16x32_bf16 v[40:43], a[32:35], v[212:215], v[40:43]
    v_mfma_f32_16x16x32_bf16 v[44:47], a[36:39], v[212:215], v[44:47]
    ds_write_b128 v19, a[140:143] offset:3072
    s_waitcnt vmcnt(10)
    ds_read_b128 v[240:243], v13 offset:24576
    ds_read_b128 v[244:247], v13 offset:26624
    ds_read_b128 v[248:251], v14 offset:24576
    ds_read_b128 v[252:255], v14 offset:26624
    v_mfma_f32_16x16x32_bf16 a[160:163], a[88:91], v[232:235], a[160:163]
    v_mfma_f32_16x16x32_bf16 a[164:167], a[92:95], v[232:235], a[164:167]
    v_mfma_f32_16x16x32_bf16 v[32:35], a[48:51], v[216:219], v[32:35]
    v_mfma_f32_16x16x32_bf16 v[36:39], a[52:55], v[216:219], v[36:39]
    v_mfma_f32_16x16x32_bf16 a[168:171], a[88:91], v[236:239], a[168:171]
    v_mfma_f32_16x16x32_bf16 a[172:175], a[92:95], v[236:239], a[172:175]
    v_mfma_f32_16x16x32_bf16 v[40:43], a[48:51], v[220:223], v[40:43]
    v_mfma_f32_16x16x32_bf16 v[44:47], a[52:55], v[220:223], v[44:47]
    s_waitcnt lgkmcnt(4)
    s_barrier
    ds_read_b128 v[128:131], v22 offset:32768
    ds_read_b128 v[132:135], v22 offset:33792
    ds_read_b128 v[136:139], v22 offset:34816
    ds_read_b128 v[140:143], v22 offset:35840
    ds_read_b128 v[144:147], v22 offset:36864
    ds_read_b128 v[148:151], v22 offset:37888
    ds_read_b128 v[152:155], v22 offset:38912
    ds_read_b128 v[156:159], v22 offset:39936
    s_waitcnt lgkmcnt(8)
    v_mfma_f32_16x16x32_bf16 a[160:163], a[104:107], v[240:243], a[160:163]
    v_mfma_f32_16x16x32_bf16 a[164:167], a[108:111], v[240:243], a[164:167]
    v_mfma_f32_16x16x32_bf16 v[32:35], a[64:67], v[224:227], v[32:35]
    v_mfma_f32_16x16x32_bf16 v[36:39], a[68:71], v[224:227], v[36:39]
    v_mfma_f32_16x16x32_bf16 a[168:171], a[104:107], v[244:247], a[168:171]
    v_mfma_f32_16x16x32_bf16 a[172:175], a[108:111], v[244:247], a[172:175]
    v_mfma_f32_16x16x32_bf16 v[40:43], a[64:67], v[228:231], v[40:43]
    v_mfma_f32_16x16x32_bf16 v[44:47], a[68:71], v[228:231], v[44:47]
    s_waitcnt lgkmcnt(0)
    v_mfma_f32_16x16x32_bf16 a[160:163], a[120:123], v[248:251], a[160:163]
    v_add_f32 v128, v128, v144
    v_add_f32 v129, v129, v145
    v_mfma_f32_16x16x32_bf16 a[164:167], a[124:127], v[248:251], a[164:167]
    v_add_f32 v130, v130, v146
    v_add_f32 v131, v131, v147
    v_mfma_f32_16x16x32_bf16 v[32:35], a[80:83], v[232:235], v[32:35]
    v_add_f32 v132, v132, v148
    v_add_f32 v133, v133, v149
    v_mfma_f32_16x16x32_bf16 v[36:39], a[84:87], v[232:235], v[36:39]
    v_add_f32 v134, v134, v150
    v_add_f32 v135, v135, v151
    v_mfma_f32_16x16x32_bf16 a[168:171], a[120:123], v[252:255], a[168:171]
    v_add_f32 v136, v136, v152
    v_add_f32 v137, v137, v153
    v_mfma_f32_16x16x32_bf16 a[172:175], a[124:127], v[252:255], a[172:175]
    v_add_f32 v138, v138, v154
    v_add_f32 v139, v139, v155
    v_mfma_f32_16x16x32_bf16 v[40:43], a[80:83], v[236:239], v[40:43]
    v_add_f32 v140, v140, v156
    v_add_f32 v141, v141, v157
    v_mfma_f32_16x16x32_bf16 v[44:47], a[84:87], v[236:239], v[44:47]
    v_add_f32 v142, v142, v158
    v_add_f32 v143, v143, v159
    ds_write_b128 v21, a[160:163] offset:0
    v_mfma_f32_16x16x32_bf16 v[32:35], a[96:99], v[240:243], v[32:35]
    v_fmac_f32 v64, v48, v128
    v_fmac_f32 v65, v49, v129
    v_mfma_f32_16x16x32_bf16 v[36:39], a[100:103], v[240:243], v[36:39]
    v_fmac_f32 v66, v50, v130
    v_fmac_f32 v67, v51, v131
    ds_write_b128 v21, a[164:167] offset:1024
    v_mfma_f32_16x16x32_bf16 v[40:43], a[96:99], v[244:247], v[40:43]
    v_fmac_f32 v68, v52, v132
    v_fmac_f32 v69, v53, v133
    v_mfma_f32_16x16x32_bf16 v[44:47], a[100:103], v[244:247], v[44:47]
    v_fmac_f32 v70, v54, v134
    v_fmac_f32 v71, v55, v135
    s_add_u32 m0, s41, 8192
    v_xor_b32 v26, 0x30000, v26
    buffer_load_dwordx4 v26, s[20:23], 0 offen offset:0  lds
    ds_write_b128 v21, a[168:171] offset:2048
    v_mfma_f32_16x16x32_bf16 v[32:35], a[112:115], v[248:251], v[32:35]
    v_fmac_f32 v72, v56, v136
    v_fmac_f32 v73, v57, v137
    v_mfma_f32_16x16x32_bf16 v[36:39], a[116:119], v[248:251], v[36:39]
    v_fmac_f32 v74, v58, v138
    v_fmac_f32 v75, v59, v139
    ds_write_b128 v21, a[172:175] offset:3072
    v_mfma_f32_16x16x32_bf16 v[40:43], a[112:115], v[252:255], v[40:43]
    v_fmac_f32 v76, v60, v140
    v_fmac_f32 v77, v61, v141
    v_mfma_f32_16x16x32_bf16 v[44:47], a[116:119], v[252:255], v[44:47]
    v_fmac_f32 v78, v62, v142
    v_fmac_f32 v79, v63, v143
    buffer_load_dwordx4 v26, s[20:23], s42 offen offset:1024  lds
    buffer_load_dwordx4 v26, s[20:23], s43 offen offset:2048  lds
    s_waitcnt lgkmcnt(0)
    s_barrier
    ds_read_b128 v[160:163], v22 offset:28672
    ds_read_b128 v[164:167], v22 offset:29696
    ds_read_b128 v[168:171], v22 offset:30720
    ds_read_b128 v[172:175], v22 offset:31744
    buffer_load_dwordx4 v26, s[20:23], s44 offen offset:3072  lds
    v_fmac_f32 v64, v48, v32
    v_fmac_f32 v65, v49, v33
    v_fmac_f32 v66, v50, v34
    v_fmac_f32 v67, v51, v35
    v_fmac_f32 v68, v52, v36
    v_fmac_f32 v69, v53, v37
    v_fmac_f32 v70, v54, v38
    v_fmac_f32 v71, v55, v39
    v_fmac_f32 v72, v56, v40
    v_fmac_f32 v73, v57, v41
    v_fmac_f32 v74, v58, v42
    v_fmac_f32 v75, v59, v43
    v_fmac_f32 v76, v60, v44
    v_fmac_f32 v77, v61, v45
    v_fmac_f32 v78, v62, v46
    v_fmac_f32 v79, v63, v47
    s_waitcnt lgkmcnt(2)
    v_fmac_f32 v64, v48, v160
    v_fmac_f32 v65, v49, v161
    v_fmac_f32 v66, v50, v162
    v_fmac_f32 v67, v51, v163
    v_fmac_f32 v68, v52, v164
    v_fmac_f32 v69, v53, v165
    v_fmac_f32 v70, v54, v166
    v_fmac_f32 v71, v55, v167
    v_cvt_pk_bf16_f32 v120, v64, v65
    v_cvt_pk_bf16_f32 v121, v66, v67
    v_cvt_pk_bf16_f32 v122, v68, v69
    v_cvt_pk_bf16_f32 v123, v70, v71
    buffer_store_dwordx4 v[120:123], v23, s[36:39], 0 offen offset:0 sc1
    s_waitcnt lgkmcnt(0)
    v_fmac_f32 v72, v56, v168
    v_fmac_f32 v73, v57, v169
    v_fmac_f32 v74, v58, v170
    v_fmac_f32 v75, v59, v171
    v_fmac_f32 v76, v60, v172
    v_fmac_f32 v77, v61, v173
    v_fmac_f32 v78, v62, v174
    v_fmac_f32 v79, v63, v175
    v_cvt_pk_bf16_f32 v124, v72, v73
    v_cvt_pk_bf16_f32 v125, v74, v75
    v_cvt_pk_bf16_f32 v126, v76, v77
    v_cvt_pk_bf16_f32 v127, v78, v79
    buffer_store_dwordx4 v[124:127], v23, s[36:39], 0 offen offset:1024 sc1
    v_lshlrev_b32 v80, 16, v104
    v_and_b32 v81, 0xffff0000, v104
    v_lshlrev_b32 v82, 16, v105
    v_and_b32 v83, 0xffff0000, v105
    v_lshlrev_b32 v84, 16, v106
    v_and_b32 v85, 0xffff0000, v106
    v_lshlrev_b32 v86, 16, v107
    v_and_b32 v87, 0xffff0000, v107
    s_waitcnt vmcnt(0)
    s_barrier
    s_atomic_swap_x2 s[4:5], s[6:7], 0x0
    s_atomic_swap_x2 s[4:5], s[6:7], 0x200
    s_atomic_swap_x2 s[4:5], s[6:7], 0x400
    s_atomic_swap_x2 s[4:5], s[6:7], 0x600
    s_add_u32 m0, s41, 12288
    v_xor_b32 v26, 0x10000, v26
    buffer_load_dwordx4 v26, s[20:23], 0 offen offset:0  lds
    buffer_load_dwordx4 v26, s[20:23], s42 offen offset:1024  lds
    buffer_load_dwordx4 v26, s[20:23], s43 offen offset:2048  lds
    buffer_load_dwordx4 v26, s[20:23], s44 offen offset:3072  lds
    s_add_u32 m0, s41, 16384
    v_xor_b32 v26, 0x70000, v26
    buffer_load_dwordx4 v26, s[20:23], 0 offen offset:0  lds
    buffer_load_dwordx4 v26, s[20:23], s42 offen offset:1024  lds
    buffer_load_dwordx4 v26, s[20:23], s43 offen offset:2048  lds
    buffer_load_dwordx4 v26, s[20:23], s44 offen offset:3072  lds
    ds_read_b64_tr_b16 a[0:1], v11 offset:0
    ds_read_b64_tr_b16 a[2:3], v11 offset:512
    ds_read_b64_tr_b16 a[4:5], v11 offset:8
    ds_read_b64_tr_b16 a[6:7], v11 offset:520
    ds_read_b64_tr_b16 a[8:9], v12 offset:0
    ds_read_b64_tr_b16 a[10:11], v12 offset:512
    ds_read_b64_tr_b16 a[12:13], v12 offset:8
    ds_read_b64_tr_b16 a[14:15], v12 offset:520
    s_add_u32 m0, s41, 20480
    v_xor_b32 v26, 0x10000, v26
    buffer_load_dwordx4 v26, s[20:23], 0 offen offset:0  lds
    buffer_load_dwordx4 v26, s[20:23], s42 offen offset:1024  lds
    buffer_load_dwordx4 v26, s[20:23], s43 offen offset:2048  lds
    buffer_load_dwordx4 v26, s[20:23], s44 offen offset:3072  lds
    ds_read_b64_tr_b16 a[16:17], v11 offset:4096
    ds_read_b64_tr_b16 a[18:19], v11 offset:4608
    ds_read_b64_tr_b16 a[20:21], v11 offset:4104
    ds_read_b64_tr_b16 a[22:23], v11 offset:4616
    ds_read_b64_tr_b16 a[24:25], v12 offset:4096
    ds_read_b64_tr_b16 a[26:27], v12 offset:4608
    ds_read_b64_tr_b16 a[28:29], v12 offset:4104
    ds_read_b64_tr_b16 a[30:31], v12 offset:4616
    s_load_dwordx8 s[8:15], s[2:3], 0x0 glc
    s_add_u32 m0, s41, 24576
    v_xor_b32 v26, 0x30000, v26
    buffer_load_dwordx4 v26, s[20:23], 0 offen offset:0  lds
    buffer_load_dwordx4 v26, s[20:23], s42 offen offset:1024  lds
    buffer_load_dwordx4 v26, s[20:23], s43 offen offset:2048  lds
    buffer_load_dwordx4 v26, s[20:23], s44 offen offset:3072  lds
    ds_read_b64_tr_b16 a[32:33], v11 offset:8192
    ds_read_b64_tr_b16 a[34:35], v11 offset:8704
    ds_read_b64_tr_b16 a[36:37], v11 offset:8200
    ds_read_b64_tr_b16 a[38:39], v11 offset:8712
    ds_read_b64_tr_b16 a[40:41], v12 offset:8192
    ds_read_b64_tr_b16 a[42:43], v12 offset:8704
    ds_read_b64_tr_b16 a[44:45], v12 offset:8200
    ds_read_b64_tr_b16 a[46:47], v12 offset:8712
    s_add_u32 m0, s41, 28672
    v_xor_b32 v26, 0x10000, v26
    buffer_load_dwordx4 v26, s[20:23], 0 offen offset:0  lds
    buffer_load_dwordx4 v26, s[20:23], s42 offen offset:1024  lds
    buffer_load_dwordx4 v26, s[20:23], s43 offen offset:2048  lds
    buffer_load_dwordx4 v26, s[20:23], s44 offen offset:3072  lds
    s_waitcnt vmcnt(16)
    ds_read_b64_tr_b16 a[48:49], v11 offset:12288
    ds_read_b64_tr_b16 a[50:51], v11 offset:12800
    ds_read_b64_tr_b16 a[52:53], v11 offset:12296
    ds_read_b64_tr_b16 a[54:55], v11 offset:12808
    ds_read_b64_tr_b16 a[56:57], v12 offset:12288
    ds_read_b64_tr_b16 a[58:59], v12 offset:12800
    ds_read_b64_tr_b16 a[60:61], v12 offset:12296
    ds_read_b64_tr_b16 a[62:63], v12 offset:12808
L_poll_1:
    s_waitcnt lgkmcnt(0)
    s_xor_b64 s[8:9], s[8:9], s[4:5]
    s_xor_b64 s[10:11], s[10:11], s[4:5]
    s_or_b64 s[8:9], s[8:9], s[10:11]
    s_xor_b64 s[12:13], s[12:13], s[4:5]
    s_or_b64 s[8:9], s[8:9], s[12:13]
    s_xor_b64 s[14:15], s[14:15], s[4:5]
    s_or_b64 s[8:9], s[8:9], s[14:15]
    s_cbranch_scc0 L_poll_ok_2
    s_load_dwordx8 s[8:15], s[2:3], 0x0 glc
    s_add_u32 s57, s57, 1
    s_cmp_lt_u32 s57, 0x40000
    s_cbranch_scc1 L_poll_1
    s_waitcnt lgkmcnt(0)
L_poll_ok_2:
    buffer_load_dwordx4 v[128:131], v17, s[36:39], s98 offen offset:0 sc1
    buffer_load_dwordx4 v[132:135], v17, s[36:39], s98 offen offset:1024 sc1
    buffer_load_dwordx4 v[136:139], v17, s[36:39], s98 offen offset:2048 sc1
    buffer_load_dwordx4 v[140:143], v17, s[36:39], s98 offen offset:3072 sc1
    buffer_load_dwordx4 v[144:147], v17, s[36:39], s99 offen offset:0 sc1
    buffer_load_dwordx4 v[148:151], v17, s[36:39], s99 offen offset:1024 sc1
    buffer_load_dwordx4 v[152:155], v17, s[36:39], s99 offen offset:2048 sc1
    buffer_load_dwordx4 v[156:159], v17, s[36:39], s99 offen offset:3072 sc1
    buffer_load_dwordx4 v[160:163], v17, s[36:39], s100 offen offset:0 sc1
    buffer_load_dwordx4 v[164:167], v17, s[36:39], s100 offen offset:1024 sc1
    s_waitcnt vmcnt(22)
    ds_read_b64_tr_b16 a[64:65], v11 offset:16384
    ds_read_b64_tr_b16 a[66:67], v11 offset:16896
    ds_read_b64_tr_b16 a[68:69], v11 offset:16392
    ds_read_b64_tr_b16 a[70:71], v11 offset:16904
    ds_read_b64_tr_b16 a[72:73], v12 offset:16384
    ds_read_b64_tr_b16 a[74:75], v12 offset:16896
    ds_read_b64_tr_b16 a[76:77], v12 offset:16392
    ds_read_b64_tr_b16 a[78:79], v12 offset:16904
    s_waitcnt vmcnt(18)
    ds_read_b64_tr_b16 a[80:81], v11 offset:20480
    ds_read_b64_tr_b16 a[82:83], v11 offset:20992
    ds_read_b64_tr_b16 a[84:85], v11 offset:20488
    ds_read_b64_tr_b16 a[86:87], v11 offset:21000
    ds_read_b64_tr_b16 a[88:89], v12 offset:20480
    ds_read_b64_tr_b16 a[90:91], v12 offset:20992
    ds_read_b64_tr_b16 a[92:93], v12 offset:20488
    ds_read_b64_tr_b16 a[94:95], v12 offset:21000
    s_waitcnt vmcnt(14)
    ds_read_b64_tr_b16 a[96:97], v11 offset:24576
    ds_read_b64_tr_b16 a[98:99], v11 offset:25088
    ds_read_b64_tr_b16 a[100:101], v11 offset:24584
    ds_read_b64_tr_b16 a[102:103], v11 offset:25096
    ds_read_b64_tr_b16 a[104:105], v12 offset:24576
    ds_read_b64_tr_b16 a[106:107], v12 offset:25088
    ds_read_b64_tr_b16 a[108:109], v12 offset:24584
    ds_read_b64_tr_b16 a[110:111], v12 offset:25096
    s_waitcnt vmcnt(10)
    ds_read_b64_tr_b16 a[112:113], v11 offset:28672
    ds_read_b64_tr_b16 a[114:115], v11 offset:29184
    ds_read_b64_tr_b16 a[116:117], v11 offset:28680
    ds_read_b64_tr_b16 a[118:119], v11 offset:29192
    ds_read_b64_tr_b16 a[120:121], v12 offset:28672
    ds_read_b64_tr_b16 a[122:123], v12 offset:29184
    ds_read_b64_tr_b16 a[124:125], v12 offset:28680
    ds_read_b64_tr_b16 a[126:127], v12 offset:29192
    s_waitcnt lgkmcnt(0)
    v_xor_b32 v26, 0x70000, v26
    v_add_u32 v26, 0x200000, v26
    s_waitcnt vmcnt(9)
    buffer_load_dwordx4 v[168:171], v17, s[36:39], s100 offen offset:2048 sc1
    v_mfma_f32_16x16x32_bf16 a[144:147], a[8:11], v[128:131], 0
    v_mfma_f32_16x16x32_bf16 a[148:151], a[12:15], v[128:131], 0
    v_mfma_f32_16x16x32_bf16 a[128:131], a[0:3], v[128:131], 0
    v_mfma_f32_16x16x32_bf16 a[132:135], a[4:7], v[128:131], 0
    s_waitcnt vmcnt(9)
    buffer_load_dwordx4 v[172:175], v17, s[36:39], s100 offen offset:3072 sc1
    v_mfma_f32_16x16x32_bf16 a[152:155], a[8:11], v[132:135], 0
    v_mfma_f32_16x16x32_bf16 a[156:159], a[12:15], v[132:135], 0
    v_mfma_f32_16x16x32_bf16 a[136:139], a[0:3], v[132:135], 0
    v_mfma_f32_16x16x32_bf16 a[140:143], a[4:7], v[132:135], 0
    s_waitcnt vmcnt(9)
    buffer_load_dwordx4 v[176:179], v17, s[36:39], s101 offen offset:0 sc1
    v_mfma_f32_16x16x32_bf16 a[144:147], a[24:27], v[136:139], a[144:147]
    v_mfma_f32_16x16x32_bf16 a[148:151], a[28:31], v[136:139], a[148:151]
    v_mfma_f32_16x16x32_bf16 a[128:131], a[16:19], v[136:139], a[128:131]
    v_mfma_f32_16x16x32_bf16 a[132:135], a[20:23], v[136:139], a[132:135]
    s_waitcnt vmcnt(9)
    buffer_load_dwordx4 v[180:183], v17, s[36:39], s101 offen offset:1024 sc1
    v_mfma_f32_16x16x32_bf16 a[152:155], a[24:27], v[140:143], a[152:155]
    v_mfma_f32_16x16x32_bf16 a[156:159], a[28:31], v[140:143], a[156:159]
    v_mfma_f32_16x16x32_bf16 a[136:139], a[16:19], v[140:143], a[136:139]
    v_mfma_f32_16x16x32_bf16 a[140:143], a[20:23], v[140:143], a[140:143]
    s_waitcnt vmcnt(9)
    buffer_load_dwordx4 v[184:187], v17, s[36:39], s101 offen offset:2048 sc1
    v_mfma_f32_16x16x32_bf16 a[144:147], a[40:43], v[144:147], a[144:147]
    v_mfma_f32_16x16x32_bf16 a[148:151], a[44:47], v[144:147], a[148:151]
    v_mfma_f32_16x16x32_bf16 a[128:131], a[32:35], v[144:147], a[128:131]
    v_mfma_f32_16x16x32_bf16 a[132:135], a[36:39], v[144:147], a[132:135]
    s_waitcnt vmcnt(9)
    buffer_load_dwordx4 v[188:191], v17, s[36:39], s101 offen offset:3072 sc1
    v_mfma_f32_16x16x32_bf16 a[152:155], a[40:43], v[148:151], a[152:155]
    v_mfma_f32_16x16x32_bf16 a[156:159], a[44:47], v[148:151], a[156:159]
    v_mfma_f32_16x16x32_bf16 a[136:139], a[32:35], v[148:151], a[136:139]
    v_mfma_f32_16x16x32_bf16 a[140:143], a[36:39], v[148:151], a[140:143]
    s_waitcnt vmcnt(9)
    buffer_load_dwordx4 v[192:195], v18, s[36:39], s98 offen offset:0 sc1
    v_mfma_f32_16x16x32_bf16 a[144:147], a[56:59], v[152:155], a[144:147]
    v_mfma_f32_16x16x32_bf16 a[148:151], a[60:63], v[152:155], a[148:151]
    v_mfma_f32_16x16x32_bf16 a[128:131], a[48:51], v[152:155], a[128:131]
    v_mfma_f32_16x16x32_bf16 a[132:135], a[52:55], v[152:155], a[132:135]
    s_waitcnt vmcnt(9)
    buffer_load_dwordx4 v[196:199], v18, s[36:39], s98 offen offset:1024 sc1
    v_mfma_f32_16x16x32_bf16 a[152:155], a[56:59], v[156:159], a[152:155]
    v_mfma_f32_16x16x32_bf16 a[156:159], a[60:63], v[156:159], a[156:159]
    v_mfma_f32_16x16x32_bf16 a[136:139], a[48:51], v[156:159], a[136:139]
    v_mfma_f32_16x16x32_bf16 a[140:143], a[52:55], v[156:159], a[140:143]
    s_waitcnt vmcnt(9)
    buffer_load_dwordx4 v[200:203], v18, s[36:39], s98 offen offset:2048 sc1
    v_mfma_f32_16x16x32_bf16 a[144:147], a[72:75], v[160:163], a[144:147]
    v_mfma_f32_16x16x32_bf16 a[148:151], a[76:79], v[160:163], a[148:151]
    v_mfma_f32_16x16x32_bf16 a[128:131], a[64:67], v[160:163], a[128:131]
    v_mfma_f32_16x16x32_bf16 a[132:135], a[68:71], v[160:163], a[132:135]
    s_waitcnt vmcnt(9)
    buffer_load_dwordx4 v[204:207], v18, s[36:39], s98 offen offset:3072 sc1
    v_mfma_f32_16x16x32_bf16 a[152:155], a[72:75], v[164:167], a[152:155]
    v_mfma_f32_16x16x32_bf16 a[156:159], a[76:79], v[164:167], a[156:159]
    v_mfma_f32_16x16x32_bf16 a[136:139], a[64:67], v[164:167], a[136:139]
    v_mfma_f32_16x16x32_bf16 a[140:143], a[68:71], v[164:167], a[140:143]
    s_waitcnt vmcnt(9)
    buffer_load_dwordx4 v[208:211], v18, s[36:39], s99 offen offset:0 sc1
    v_mfma_f32_16x16x32_bf16 a[144:147], a[88:91], v[168:171], a[144:147]
    v_mfma_f32_16x16x32_bf16 a[148:151], a[92:95], v[168:171], a[148:151]
    v_mfma_f32_16x16x32_bf16 a[128:131], a[80:83], v[168:171], a[128:131]
    v_mfma_f32_16x16x32_bf16 a[132:135], a[84:87], v[168:171], a[132:135]
    s_waitcnt vmcnt(9)
    buffer_load_dwordx4 v[212:215], v18, s[36:39], s99 offen offset:1024 sc1
    v_mfma_f32_16x16x32_bf16 a[152:155], a[88:91], v[172:175], a[152:155]
    v_mfma_f32_16x16x32_bf16 a[156:159], a[92:95], v[172:175], a[156:159]
    v_mfma_f32_16x16x32_bf16 a[136:139], a[80:83], v[172:175], a[136:139]
    v_mfma_f32_16x16x32_bf16 a[140:143], a[84:87], v[172:175], a[140:143]
    s_waitcnt vmcnt(9)
    buffer_load_dwordx4 v[216:219], v18, s[36:39], s99 offen offset:2048 sc1
    v_mfma_f32_16x16x32_bf16 a[144:147], a[104:107], v[176:179], a[144:147]
    v_mfma_f32_16x16x32_bf16 a[148:151], a[108:111], v[176:179], a[148:151]
    v_mfma_f32_16x16x32_bf16 a[128:131], a[96:99], v[176:179], a[128:131]
    v_mfma_f32_16x16x32_bf16 a[132:135], a[100:103], v[176:179], a[132:135]
    s_waitcnt vmcnt(9)
    buffer_load_dwordx4 v[220:223], v18, s[36:39], s99 offen offset:3072 sc1
    v_mfma_f32_16x16x32_bf16 a[152:155], a[104:107], v[180:183], a[152:155]
    v_mfma_f32_16x16x32_bf16 a[156:159], a[108:111], v[180:183], a[156:159]
    v_mfma_f32_16x16x32_bf16 a[136:139], a[96:99], v[180:183], a[136:139]
    v_mfma_f32_16x16x32_bf16 a[140:143], a[100:103], v[180:183], a[140:143]
    s_waitcnt vmcnt(9)
    buffer_load_dwordx4 v[224:227], v18, s[36:39], s100 offen offset:0 sc1
    v_mfma_f32_16x16x32_bf16 a[144:147], a[120:123], v[184:187], a[144:147]
    v_mfma_f32_16x16x32_bf16 a[148:151], a[124:127], v[184:187], a[148:151]
    v_mfma_f32_16x16x32_bf16 a[128:131], a[112:115], v[184:187], a[128:131]
    v_mfma_f32_16x16x32_bf16 a[132:135], a[116:119], v[184:187], a[132:135]
    s_waitcnt vmcnt(9)
    buffer_load_dwordx4 v[228:231], v18, s[36:39], s100 offen offset:1024 sc1
    v_mfma_f32_16x16x32_bf16 a[152:155], a[120:123], v[188:191], a[152:155]
    v_mfma_f32_16x16x32_bf16 a[156:159], a[124:127], v[188:191], a[156:159]
    v_mfma_f32_16x16x32_bf16 a[136:139], a[112:115], v[188:191], a[136:139]
    v_mfma_f32_16x16x32_bf16 a[140:143], a[116:119], v[188:191], a[140:143]
    s_waitcnt vmcnt(9)
    buffer_load_dwordx4 v[232:235], v18, s[36:39], s100 offen offset:2048 sc1
    v_mfma_f32_16x16x32_bf16 a[160:163], a[8:11], v[192:195], 0
    v_mfma_f32_16x16x32_bf16 a[164:167], a[12:15], v[192:195], 0
    s_waitcnt vmcnt(9)
    buffer_load_dwordx4 v[236:239], v18, s[36:39], s100 offen offset:3072 sc1
    v_mfma_f32_16x16x32_bf16 a[168:171], a[8:11], v[196:199], 0
    v_mfma_f32_16x16x32_bf16 a[172:175], a[12:15], v[196:199], 0
    ds_write_b128 v20, a[144:147] offset:0
    s_waitcnt vmcnt(9)
    buffer_load_dwordx4 v[240:243], v18, s[36:39], s101 offen offset:0 sc1
    v_mfma_f32_16x16x32_bf16 a[160:163], a[24:27], v[200:203], a[160:163]
    v_mfma_f32_16x16x32_bf16 a[164:167], a[28:31], v[200:203], a[164:167]
    s_waitcnt vmcnt(9)
    buffer_load_dwordx4 v[244:247], v18, s[36:39], s101 offen offset:1024 sc1
    v_mfma_f32_16x16x32_bf16 a[168:171], a[24:27], v[204:207], a[168:171]
    v_mfma_f32_16x16x32_bf16 a[172:175], a[28:31], v[204:207], a[172:175]
    ds_write_b128 v20, a[148:151] offset:1024
    s_waitcnt vmcnt(9)
    buffer_load_dwordx4 v[248:251], v18, s[36:39], s101 offen offset:2048 sc1
    v_mfma_f32_16x16x32_bf16 a[160:163], a[40:43], v[208:211], a[160:163]
    v_mfma_f32_16x16x32_bf16 a[164:167], a[44:47], v[208:211], a[164:167]
    v_mfma_f32_16x16x32_bf16 v[32:35], a[0:3], v[192:195], v[80:83]
    v_mfma_f32_16x16x32_bf16 v[36:39], a[4:7], v[192:195], v[84:87]
    ds_write_b128 v20, a[152:155] offset:2048
    s_waitcnt vmcnt(9)
    buffer_load_dwordx4 v[252:255], v18, s[36:39], s101 offen offset:3072 sc1
    v_add_u32 v17, 0x200000, v17
    v_add_u32 v18, 0x200000, v18
    v_mfma_f32_16x16x32_bf16 a[168:171], a[40:43], v[212:215], a[168:171]
    v_mfma_f32_16x16x32_bf16 a[172:175], a[44:47], v[212:215], a[172:175]
    v_mfma_f32_16x16x32_bf16 v[40:43], a[0:3], v[196:199], v[80:83]
    v_mfma_f32_16x16x32_bf16 v[44:47], a[4:7], v[196:199], v[84:87]
    ds_write_b128 v20, a[156:159] offset:3072
    s_waitcnt vmcnt(9)
    s_add_u32 m0, s41, 0
    s_nop 0
    buffer_load_dwordx4 v26, s[20:23], 0 offen offset:0  lds
    v_mfma_f32_16x16x32_bf16 a[160:163], a[56:59], v[216:219], a[160:163]
    v_mfma_f32_16x16x32_bf16 a[164:167], a[60:63], v[216:219], a[164:167]
    v_mfma_f32_16x16x32_bf16 v[32:35], a[16:19], v[200:203], v[32:35]
    v_mfma_f32_16x16x32_bf16 v[36:39], a[20:23], v[200:203], v[36:39]
    ds_write_b128 v19, a[128:131] offset:0
    s_waitcnt vmcnt(9)
    buffer_load_dwordx4 v26, s[20:23], s42 offen offset:1024  lds
    v_mfma_f32_16x16x32_bf16 a[168:171], a[56:59], v[220:223], a[168:171]
    v_mfma_f32_16x16x32_bf16 a[172:175], a[60:63], v[220:223], a[172:175]
    v_mfma_f32_16x16x32_bf16 v[40:43], a[16:19], v[204:207], v[40:43]
    v_mfma_f32_16x16x32_bf16 v[44:47], a[20:23], v[204:207], v[44:47]
    ds_write_b128 v19, a[132:135] offset:1024
    s_waitcnt vmcnt(9)
    buffer_load_dwordx4 v26, s[20:23], s43 offen offset:2048  lds
    v_mfma_f32_16x16x32_bf16 a[160:163], a[72:75], v[224:227], a[160:163]
    v_mfma_f32_16x16x32_bf16 a[164:167], a[76:79], v[224:227], a[164:167]
    v_mfma_f32_16x16x32_bf16 v[32:35], a[32:35], v[208:211], v[32:35]
    v_mfma_f32_16x16x32_bf16 v[36:39], a[36:39], v[208:211], v[36:39]
    ds_write_b128 v19, a[136:139] offset:2048
    s_waitcnt vmcnt(9)
    buffer_load_dwordx4 v26, s[20:23], s44 offen offset:3072  lds
    buffer_load_dword v30, v27, s[20:23], s46 offen
    v_mfma_f32_16x16x32_bf16 a[168:171], a[72:75], v[228:231], a[168:171]
    v_mfma_f32_16x16x32_bf16 a[172:175], a[76:79], v[228:231], a[172:175]
    v_mfma_f32_16x16x32_bf16 v[40:43], a[32:35], v[212:215], v[40:43]
    v_mfma_f32_16x16x32_bf16 v[44:47], a[36:39], v[212:215], v[44:47]
    ds_write_b128 v19, a[140:143] offset:3072
    s_waitcnt vmcnt(10)
    s_add_u32 m0, s41, 4096
    v_xor_b32 v26, 0x10000, v26
    buffer_load_dwordx4 v26, s[20:23], 0 offen offset:0  lds
    v_mfma_f32_16x16x32_bf16 a[160:163], a[88:91], v[232:235], a[160:163]
    v_mfma_f32_16x16x32_bf16 a[164:167], a[92:95], v[232:235], a[164:167]
    v_mfma_f32_16x16x32_bf16 v[32:35], a[48:51], v[216:219], v[32:35]
    v_mfma_f32_16x16x32_bf16 v[36:39], a[52:55], v[216:219], v[36:39]
    s_waitcnt vmcnt(10)
    buffer_load_dwordx4 v26, s[20:23], s42 offen offset:1024  lds
    v_mfma_f32_16x16x32_bf16 a[168:171], a[88:91], v[236:239], a[168:171]
    v_mfma_f32_16x16x32_bf16 a[172:175], a[92:95], v[236:239], a[172:175]
    v_mfma_f32_16x16x32_bf16 v[40:43], a[48:51], v[220:223], v[40:43]
    v_mfma_f32_16x16x32_bf16 v[44:47], a[52:55], v[220:223], v[44:47]
    s_waitcnt vmcnt(10)
    buffer_load_dwordx4 v26, s[20:23], s43 offen offset:2048  lds
    s_waitcnt lgkmcnt(0)
    s_barrier
    ds_read_b128 v[128:131], v22 offset:32768
    ds_read_b128 v[132:135], v22 offset:33792
    ds_read_b128 v[136:139], v22 offset:34816
    ds_read_b128 v[140:143], v22 offset:35840
    ds_read_b128 v[144:147], v22 offset:36864
    ds_read_b128 v[148:151], v22 offset:37888
    ds_read_b128 v[152:155], v22 offset:38912
    ds_read_b128 v[156:159], v22 offset:39936
    v_mfma_f32_16x16x32_bf16 a[160:163], a[104:107], v[240:243], a[160:163]
    v_mfma_f32_16x16x32_bf16 a[164:167], a[108:111], v[240:243], a[164:167]
    v_mfma_f32_16x16x32_bf16 v[32:35], a[64:67], v[224:227], v[32:35]
    v_mfma_f32_16x16x32_bf16 v[36:39], a[68:71], v[224:227], v[36:39]
    s_waitcnt vmcnt(10)
    buffer_load_dwordx4 v26, s[20:23], s44 offen offset:3072  lds
    v_mfma_f32_16x16x32_bf16 a[168:171], a[104:107], v[244:247], a[168:171]
    v_mfma_f32_16x16x32_bf16 a[172:175], a[108:111], v[244:247], a[172:175]
    v_mfma_f32_16x16x32_bf16 v[40:43], a[64:67], v[228:231], v[40:43]
    v_mfma_f32_16x16x32_bf16 v[44:47], a[68:71], v[228:231], v[44:47]
    s_waitcnt vmcnt(10)
    s_waitcnt lgkmcnt(0)
    v_mfma_f32_16x16x32_bf16 a[160:163], a[120:123], v[248:251], a[160:163]
    v_add_f32 v128, v128, v144
    v_add_f32 v129, v129, v145
    v_mfma_f32_16x16x32_bf16 a[164:167], a[124:127], v[248:251], a[164:167]
    v_add_f32 v130, v130, v146
    v_add_f32 v131, v131, v147
    v_mfma_f32_16x16x32_bf16 v[32:35], a[80:83], v[232:235], v[32:35]
    v_add_f32 v132, v132, v148
    v_add_f32 v133, v133, v149
    v_mfma_f32_16x16x32_bf16 v[36:39], a[84:87], v[232:235], v[36:39]
    v_add_f32 v134, v134, v150
    v_add_f32 v135, v135, v151
    s_waitcnt vmcnt(9)
    v_mfma_f32_16x16x32_bf16 a[168:171], a[120:123], v[252:255], a[168:171]
    v_add_f32 v136, v136, v152
    v_add_f32 v137, v137, v153
    v_mfma_f32_16x16x32_bf16 a[172:175], a[124:127], v[252:255], a[172:175]
    v_add_f32 v138, v138, v154
    v_add_f32 v139, v139, v155
    v_mfma_f32_16x16x32_bf16 v[40:43], a[80:83], v[236:239], v[40:43]
    v_add_f32 v140, v140, v156
    v_add_f32 v141, v141, v157
    v_mfma_f32_16x16x32_bf16 v[44:47], a[84:87], v[236:239], v[44:47]
    v_add_f32 v142, v142, v158
    v_add_f32 v143, v143, v159
    ds_write_b128 v21, a[160:163] offset:0
    v_mfma_f32_16x16x32_bf16 v[32:35], a[96:99], v[240:243], v[32:35]
    v_fmac_f32 v64, v48, v128
    v_fmac_f32 v65, v49, v129
    v_mfma_f32_16x16x32_bf16 v[36:39], a[100:103], v[240:243], v[36:39]
    v_fmac_f32 v66, v50, v130
    v_fmac_f32 v67, v51, v131
    ds_write_b128 v21, a[164:167] offset:1024
    v_mfma_f32_16x16x32_bf16 v[40:43], a[96:99], v[244:247], v[40:43]
    v_fmac_f32 v68, v52, v132
    v_fmac_f32 v69, v53, v133
    v_mfma_f32_16x16x32_bf16 v[44:47], a[100:103], v[244:247], v[44:47]
    v_fmac_f32 v70, v54, v134
    v_fmac_f32 v71, v55, v135
    s_add_u32 m0, s41, 8192
    v_xor_b32 v26, 0x30000, v26
    buffer_load_dwordx4 v26, s[20:23], 0 offen offset:0  lds
    ds_write_b128 v21, a[168:171] offset:2048
    v_mfma_f32_16x16x32_bf16 v[32:35], a[112:115], v[248:251], v[32:35]
    v_fmac_f32 v72, v56, v136
    v_fmac_f32 v73, v57, v137
    v_mfma_f32_16x16x32_bf16 v[36:39], a[116:119], v[248:251], v[36:39]
    v_fmac_f32 v74, v58, v138
    v_fmac_f32 v75, v59, v139
    ds_write_b128 v21, a[172:175] offset:3072
    v_mfma_f32_16x16x32_bf16 v[40:43], a[112:115], v[252:255], v[40:43]
    v_fmac_f32 v76, v60, v140
    v_fmac_f32 v77, v61, v141
    v_mfma_f32_16x16x32_bf16 v[44:47], a[116:119], v[252:255], v[44:47]
    v_fmac_f32 v78, v62, v142
    v_fmac_f32 v79, v63, v143
    buffer_load_dwordx4 v26, s[20:23], s42 offen offset:1024  lds
    buffer_load_dwordx4 v26, s[20:23], s43 offen offset:2048  lds
    s_waitcnt lgkmcnt(0)
    s_barrier
    ds_read_b128 v[160:163], v22 offset:28672
    ds_read_b128 v[164:167], v22 offset:29696
    ds_read_b128 v[168:171], v22 offset:30720
    ds_read_b128 v[172:175], v22 offset:31744
    buffer_load_dwordx4 v26, s[20:23], s44 offen offset:3072  lds
    v_fmac_f32 v64, v48, v32
    v_fmac_f32 v65, v49, v33
    v_fmac_f32 v66, v50, v34
    v_fmac_f32 v67, v51, v35
    v_fmac_f32 v68, v52, v36
    v_fmac_f32 v69, v53, v37
    v_fmac_f32 v70, v54, v38
    v_fmac_f32 v71, v55, v39
    v_fmac_f32 v72, v56, v40
    v_fmac_f32 v73, v57, v41
    v_fmac_f32 v74, v58, v42
    v_fmac_f32 v75, v59, v43
    v_fmac_f32 v76, v60, v44
    v_fmac_f32 v77, v61, v45
    v_fmac_f32 v78, v62, v46
    v_fmac_f32 v79, v63, v47
    s_waitcnt lgkmcnt(2)
    v_fmac_f32 v64, v48, v160
    v_fmac_f32 v65, v49, v161
    v_fmac_f32 v66, v50, v162
    v_fmac_f32 v67, v51, v163
    v_fmac_f32 v68, v52, v164
    v_fmac_f32 v69, v53, v165
    v_fmac_f32 v70, v54, v166
    v_fmac_f32 v71, v55, v167
    v_cvt_pk_bf16_f32 v120, v64, v65
    v_cvt_pk_bf16_f32 v121, v66, v67
    v_cvt_pk_bf16_f32 v122, v68, v69
    v_cvt_pk_bf16_f32 v123, v70, v71
    buffer_store_dwordx4 v[120:123], v23, s[36:39], s56 offen offset:0 sc1
    s_waitcnt lgkmcnt(0)
    v_fmac_f32 v72, v56, v168
    v_fmac_f32 v73, v57, v169
    v_fmac_f32 v74, v58, v170
    v_fmac_f32 v75, v59, v171
    v_fmac_f32 v76, v60, v172
    v_fmac_f32 v77, v61, v173
    v_fmac_f32 v78, v62, v174
    v_fmac_f32 v79, v63, v175
    v_cvt_pk_bf16_f32 v124, v72, v73
    v_cvt_pk_bf16_f32 v125, v74, v75
    v_cvt_pk_bf16_f32 v126, v76, v77
    v_cvt_pk_bf16_f32 v127, v78, v79
    buffer_store_dwordx4 v[124:127], v23, s[36:39], s56 offen offset:1024 sc1
    v_lshlrev_b32 v80, 16, v112
    v_and_b32 v81, 0xffff0000, v112
    v_lshlrev_b32 v82, 16, v113
    v_and_b32 v83, 0xffff0000, v113
    v_lshlrev_b32 v84, 16, v114
    v_and_b32 v85, 0xffff0000, v114
    v_lshlrev_b32 v86, 16, v115
    v_and_b32 v87, 0xffff0000, v115
    s_waitcnt vmcnt(0)
    s_barrier
    s_atomic_swap_x2 s[4:5], s[6:7], 0x40000
    s_atomic_swap_x2 s[4:5], s[6:7], 0x40200
    s_atomic_swap_x2 s[4:5], s[6:7], 0x40400
    s_atomic_swap_x2 s[4:5], s[6:7], 0x40600
    s_add_u32 m0, s41, 12288
    v_xor_b32 v26, 0x10000, v26
    buffer_load_dwordx4 v26, s[20:23], 0 offen offset:0  lds
    buffer_load_dwordx4 v26, s[20:23], s42 offen offset:1024  lds
    buffer_load_dwordx4 v26, s[20:23], s43 offen offset:2048  lds
    buffer_load_dwordx4 v26, s[20:23], s44 offen offset:3072  lds
    s_add_u32 m0, s41, 16384
    v_xor_b32 v26, 0x70000, v26
    buffer_load_dwordx4 v26, s[20:23], 0 offen offset:0  lds
    buffer_load_dwordx4 v26, s[20:23], s42 offen offset:1024  lds
    buffer_load_dwordx4 v26, s[20:23], s43 offen offset:2048  lds
    buffer_load_dwordx4 v26, s[20:23], s44 offen offset:3072  lds
    ds_read_b64_tr_b16 a[0:1], v11 offset:0
    ds_read_b64_tr_b16 a[2:3], v11 offset:512
    ds_read_b64_tr_b16 a[4:5], v11 offset:8
    ds_read_b64_tr_b16 a[6:7], v11 offset:520
    ds_read_b64_tr_b16 a[8:9], v12 offset:0
    ds_read_b64_tr_b16 a[10:11], v12 offset:512
    ds_read_b64_tr_b16 a[12:13], v12 offset:8
    ds_read_b64_tr_b16 a[14:15], v12 offset:520
    s_add_u32 m0, s41, 20480
    v_xor_b32 v26, 0x10000, v26
    buffer_load_dwordx4 v26, s[20:23], 0 offen offset:0  lds
    buffer_load_dwordx4 v26, s[20:23], s42 offen offset:1024  lds
    buffer_load_dwordx4 v26, s[20:23], s43 offen offset:2048  lds
    buffer_load_dwordx4 v26, s[20:23], s44 offen offset:3072  lds
    ds_read_b64_tr_b16 a[16:17], v11 offset:4096
    ds_read_b64_tr_b16 a[18:19], v11 offset:4608
    ds_read_b64_tr_b16 a[20:21], v11 offset:4104
    ds_read_b64_tr_b16 a[22:23], v11 offset:4616
    ds_read_b64_tr_b16 a[24:25], v12 offset:4096
    ds_read_b64_tr_b16 a[26:27], v12 offset:4608
    ds_read_b64_tr_b16 a[28:29], v12 offset:4104
    ds_read_b64_tr_b16 a[30:31], v12 offset:4616
    s_load_dwordx8 s[8:15], s[2:3], 0x40000 glc
    s_add_u32 m0, s41, 24576
    v_xor_b32 v26, 0x30000, v26
    buffer_load_dwordx4 v26, s[20:23], 0 offen offset:0  lds
    buffer_load_dwordx4 v26, s[20:23], s42 offen offset:1024  lds
    buffer_load_dwordx4 v26, s[20:23], s43 offen offset:2048  lds
    buffer_load_dwordx4 v26, s[20:23], s44 offen offset:3072  lds
    ds_read_b64_tr_b16 a[32:33], v11 offset:8192
    ds_read_b64_tr_b16 a[34:35], v11 offset:8704
    ds_read_b64_tr_b16 a[36:37], v11 offset:8200
    ds_read_b64_tr_b16 a[38:39], v11 offset:8712
    ds_read_b64_tr_b16 a[40:41], v12 offset:8192
    ds_read_b64_tr_b16 a[42:43], v12 offset:8704
    ds_read_b64_tr_b16 a[44:45], v12 offset:8200
    ds_read_b64_tr_b16 a[46:47], v12 offset:8712
    s_add_u32 m0, s41, 28672
    v_xor_b32 v26, 0x10000, v26
    buffer_load_dwordx4 v26, s[20:23], 0 offen offset:0  lds
    buffer_load_dwordx4 v26, s[20:23], s42 offen offset:1024  lds
    buffer_load_dwordx4 v26, s[20:23], s43 offen offset:2048  lds
    buffer_load_dwordx4 v26, s[20:23], s44 offen offset:3072  lds
    s_waitcnt vmcnt(16)
    ds_read_b64_tr_b16 a[48:49], v11 offset:12288
    ds_read_b64_tr_b16 a[50:51], v11 offset:12800
    ds_read_b64_tr_b16 a[52:53], v11 offset:12296
    ds_read_b64_tr_b16 a[54:55], v11 offset:12808
    ds_read_b64_tr_b16 a[56:57], v12 offset:12288
    ds_read_b64_tr_b16 a[58:59], v12 offset:12800
    ds_read_b64_tr_b16 a[60:61], v12 offset:12296
    ds_read_b64_tr_b16 a[62:63], v12 offset:12808
L_poll_3:
    s_waitcnt lgkmcnt(0)
    s_xor_b64 s[8:9], s[8:9], s[4:5]
    s_xor_b64 s[10:11], s[10:11], s[4:5]
    s_or_b64 s[8:9], s[8:9], s[10:11]
    s_xor_b64 s[12:13], s[12:13], s[4:5]
    s_or_b64 s[8:9], s[8:9], s[12:13]
    s_xor_b64 s[14:15], s[14:15], s[4:5]
    s_or_b64 s[8:9], s[8:9], s[14:15]
    s_cbranch_scc0 L_poll_ok_4
    s_load_dwordx8 s[8:15], s[2:3], 0x40000 glc
    s_add_u32 s57, s57, 1
    s_cmp_lt_u32 s57, 0x40000
    s_cbranch_scc1 L_poll_3
    s_waitcnt lgkmcnt(0)
L_poll_ok_4:
    buffer_load_dwordx4 v[128:131], v17, s[36:39], s98 offen offset:0 sc1
    buffer_load_dwordx4 v[132:135], v17, s[36:39], s98 offen offset:1024 sc1
    buffer_load_dwordx4 v[136:139], v17, s[36:39], s98 offen offset:2048 sc1
    buffer_load_dwordx4 v[140:143], v17, s[36:39], s98 offen offset:3072 sc1
    buffer_load_dwordx4 v[144:147], v17, s[36:39], s99 offen offset:0 sc1
    buffer_load_dwordx4 v[148:151], v17, s[36:39], s99 offen offset:1024 sc1
    buffer_load_dwordx4 v[152:155], v17, s[36:39], s99 offen offset:2048 sc1
    buffer_load_dwordx4 v[156:159], v17, s[36:39], s99 offen offset:3072 sc1
    buffer_load_dwordx4 v[160:163], v17, s[36:39], s100 offen offset:0 sc1
    buffer_load_dwordx4 v[164:167], v17, s[36:39], s100 offen offset:1024 sc1
    s_waitcnt vmcnt(22)
    ds_read_b64_tr_b16 a[64:65], v11 offset:16384
    ds_read_b64_tr_b16 a[66:67], v11 offset:16896
    ds_read_b64_tr_b16 a[68:69], v11 offset:16392
    ds_read_b64_tr_b16 a[70:71], v11 offset:16904
    ds_read_b64_tr_b16 a[72:73], v12 offset:16384
    ds_read_b64_tr_b16 a[74:75], v12 offset:16896
    ds_read_b64_tr_b16 a[76:77], v12 offset:16392
    ds_read_b64_tr_b16 a[78:79], v12 offset:16904
    s_waitcnt vmcnt(18)
    ds_read_b64_tr_b16 a[80:81], v11 offset:20480
    ds_read_b64_tr_b16 a[82:83], v11 offset:20992
    ds_read_b64_tr_b16 a[84:85], v11 offset:20488
    ds_read_b64_tr_b16 a[86:87], v11 offset:21000
    ds_read_b64_tr_b16 a[88:89], v12 offset:20480
    ds_read_b64_tr_b16 a[90:91], v12 offset:20992
    ds_read_b64_tr_b16 a[92:93], v12 offset:20488
    ds_read_b64_tr_b16 a[94:95], v12 offset:21000
    s_waitcnt vmcnt(14)
    ds_read_b64_tr_b16 a[96:97], v11 offset:24576
    ds_read_b64_tr_b16 a[98:99], v11 offset:25088
    ds_read_b64_tr_b16 a[100:101], v11 offset:24584
    ds_read_b64_tr_b16 a[102:103], v11 offset:25096
    ds_read_b64_tr_b16 a[104:105], v12 offset:24576
    ds_read_b64_tr_b16 a[106:107], v12 offset:25088
    ds_read_b64_tr_b16 a[108:109], v12 offset:24584
    ds_read_b64_tr_b16 a[110:111], v12 offset:25096
    s_waitcnt vmcnt(10)
    ds_read_b64_tr_b16 a[112:113], v11 offset:28672
    ds_read_b64_tr_b16 a[114:115], v11 offset:29184
    ds_read_b64_tr_b16 a[116:117], v11 offset:28680
    ds_read_b64_tr_b16 a[118:119], v11 offset:29192
    ds_read_b64_tr_b16 a[120:121], v12 offset:28672
    ds_read_b64_tr_b16 a[122:123], v12 offset:29184
    ds_read_b64_tr_b16 a[124:125], v12 offset:28680
    ds_read_b64_tr_b16 a[126:127], v12 offset:29192
    s_waitcnt lgkmcnt(0)
L_join:
    s_waitcnt vmcnt(9)
    buffer_load_dwordx4 v[168:171], v17, s[36:39], s100 offen offset:2048 sc1
    v_mfma_f32_16x16x32_bf16 a[144:147], a[8:11], v[128:131], 0
    v_mfma_f32_16x16x32_bf16 a[148:151], a[12:15], v[128:131], 0
    v_mfma_f32_16x16x32_bf16 a[128:131], a[0:3], v[128:131], 0
    v_mfma_f32_16x16x32_bf16 a[132:135], a[4:7], v[128:131], 0
    s_waitcnt vmcnt(9)
    buffer_load_dwordx4 v[172:175], v17, s[36:39], s100 offen offset:3072 sc1
    v_mfma_f32_16x16x32_bf16 a[152:155], a[8:11], v[132:135], 0
    v_mfma_f32_16x16x32_bf16 a[156:159], a[12:15], v[132:135], 0
    v_mfma_f32_16x16x32_bf16 a[136:139], a[0:3], v[132:135], 0
    v_mfma_f32_16x16x32_bf16 a[140:143], a[4:7], v[132:135], 0
    s_waitcnt vmcnt(9)
    buffer_load_dwordx4 v[176:179], v17, s[36:39], s101 offen offset:0 sc1
    v_mfma_f32_16x16x32_bf16 a[144:147], a[24:27], v[136:139], a[144:147]
    v_mfma_f32_16x16x32_bf16 a[148:151], a[28:31], v[136:139], a[148:151]
    v_mfma_f32_16x16x32_bf16 a[128:131], a[16:19], v[136:139], a[128:131]
    v_mfma_f32_16x16x32_bf16 a[132:135], a[20:23], v[136:139], a[132:135]
    s_waitcnt vmcnt(9)
    buffer_load_dwordx4 v[180:183], v17, s[36:39], s101 offen offset:1024 sc1
    v_mfma_f32_16x16x32_bf16 a[152:155], a[24:27], v[140:143], a[152:155]
    v_mfma_f32_16x16x32_bf16 a[156:159], a[28:31], v[140:143], a[156:159]
    v_mfma_f32_16x16x32_bf16 a[136:139], a[16:19], v[140:143], a[136:139]
    v_mfma_f32_16x16x32_bf16 a[140:143], a[20:23], v[140:143], a[140:143]
    s_waitcnt vmcnt(9)
    buffer_load_dwordx4 v[184:187], v17, s[36:39], s101 offen offset:2048 sc1
    v_mfma_f32_16x16x32_bf16 a[144:147], a[40:43], v[144:147], a[144:147]
    v_mfma_f32_16x16x32_bf16 a[148:151], a[44:47], v[144:147], a[148:151]
    v_mfma_f32_16x16x32_bf16 a[128:131], a[32:35], v[144:147], a[128:131]
    v_mfma_f32_16x16x32_bf16 a[132:135], a[36:39], v[144:147], a[132:135]
    s_waitcnt vmcnt(9)
    buffer_load_dwordx4 v[188:191], v17, s[36:39], s101 offen offset:3072 sc1
    v_mfma_f32_16x16x32_bf16 a[152:155], a[40:43], v[148:151], a[152:155]
    v_mfma_f32_16x16x32_bf16 a[156:159], a[44:47], v[148:151], a[156:159]
    v_mfma_f32_16x16x32_bf16 a[136:139], a[32:35], v[148:151], a[136:139]
    v_mfma_f32_16x16x32_bf16 a[140:143], a[36:39], v[148:151], a[140:143]
    s_waitcnt vmcnt(9)
    buffer_load_dwordx4 v[192:195], v18, s[36:39], s98 offen offset:0 sc1
    v_mfma_f32_16x16x32_bf16 a[144:147], a[56:59], v[152:155], a[144:147]
    v_mfma_f32_16x16x32_bf16 a[148:151], a[60:63], v[152:155], a[148:151]
    v_mfma_f32_16x16x32_bf16 a[128:131], a[48:51], v[152:155], a[128:131]
    v_mfma_f32_16x16x32_bf16 a[132:135], a[52:55], v[152:155], a[132:135]
    s_waitcnt vmcnt(9)
    buffer_load_dwordx4 v[196:199], v18, s[36:39], s98 offen offset:1024 sc1
    v_mfma_f32_16x16x32_bf16 a[152:155], a[56:59], v[156:159], a[152:155]
    v_mfma_f32_16x16x32_bf16 a[156:159], a[60:63], v[156:159], a[156:159]
    v_mfma_f32_16x16x32_bf16 a[136:139], a[48:51], v[156:159], a[136:139]
    v_mfma_f32_16x16x32_bf16 a[140:143], a[52:55], v[156:159], a[140:143]
    s_waitcnt vmcnt(9)
    buffer_load_dwordx4 v[200:203], v18, s[36:39], s98 offen offset:2048 sc1
    v_mfma_f32_16x16x32_bf16 a[144:147], a[72:75], v[160:163], a[144:147]
    v_mfma_f32_16x16x32_bf16 a[148:151], a[76:79], v[160:163], a[148:151]
    v_mfma_f32_16x16x32_bf16 a[128:131], a[64:67], v[160:163], a[128:131]
    v_mfma_f32_16x16x32_bf16 a[132:135], a[68:71], v[160:163], a[132:135]
    s_waitcnt vmcnt(9)
    buffer_load_dwordx4 v[204:207], v18, s[36:39], s98 offen offset:3072 sc1
    v_mfma_f32_16x16x32_bf16 a[152:155], a[72:75], v[164:167], a[152:155]
    v_mfma_f32_16x16x32_bf16 a[156:159], a[76:79], v[164:167], a[156:159]
    v_mfma_f32_16x16x32_bf16 a[136:139], a[64:67], v[164:167], a[136:139]
    v_mfma_f32_16x16x32_bf16 a[140:143], a[68:71], v[164:167], a[140:143]
    s_waitcnt vmcnt(9)
    buffer_load_dwordx4 v[208:211], v18, s[36:39], s99 offen offset:0 sc1
    v_mfma_f32_16x16x32_bf16 a[144:147], a[88:91], v[168:171], a[144:147]
    v_mfma_f32_16x16x32_bf16 a[148:151], a[92:95], v[168:171], a[148:151]
    v_mfma_f32_16x16x32_bf16 a[128:131], a[80:83], v[168:171], a[128:131]
    v_mfma_f32_16x16x32_bf16 a[132:135], a[84:87], v[168:171], a[132:135]
    s_waitcnt vmcnt(9)
    buffer_load_dwordx4 v[212:215], v18, s[36:39], s99 offen offset:1024 sc1
    v_mfma_f32_16x16x32_bf16 a[152:155], a[88:91], v[172:175], a[152:155]
    v_mfma_f32_16x16x32_bf16 a[156:159], a[92:95], v[172:175], a[156:159]
    v_mfma_f32_16x16x32_bf16 a[136:139], a[80:83], v[172:175], a[136:139]
    v_mfma_f32_16x16x32_bf16 a[140:143], a[84:87], v[172:175], a[140:143]
    s_waitcnt vmcnt(9)
    buffer_load_dwordx4 v[216:219], v18, s[36:39], s99 offen offset:2048 sc1
    v_mfma_f32_16x16x32_bf16 a[144:147], a[104:107], v[176:179], a[144:147]
    v_mfma_f32_16x16x32_bf16 a[148:151], a[108:111], v[176:179], a[148:151]
    v_mfma_f32_16x16x32_bf16 a[128:131], a[96:99], v[176:179], a[128:131]
    v_mfma_f32_16x16x32_bf16 a[132:135], a[100:103], v[176:179], a[132:135]
    s_waitcnt vmcnt(9)
    buffer_load_dwordx4 v[220:223], v18, s[36:39], s99 offen offset:3072 sc1
    v_mfma_f32_16x16x32_bf16 a[152:155], a[104:107], v[180:183], a[152:155]
    v_mfma_f32_16x16x32_bf16 a[156:159], a[108:111], v[180:183], a[156:159]
    v_mfma_f32_16x16x32_bf16 a[136:139], a[96:99], v[180:183], a[136:139]
    v_mfma_f32_16x16x32_bf16 a[140:143], a[100:103], v[180:183], a[140:143]
    s_waitcnt vmcnt(9)
    buffer_load_dwordx4 v[224:227], v18, s[36:39], s100 offen offset:0 sc1
    v_mfma_f32_16x16x32_bf16 a[144:147], a[120:123], v[184:187], a[144:147]
    v_mfma_f32_16x16x32_bf16 a[148:151], a[124:127], v[184:187], a[148:151]
    v_mfma_f32_16x16x32_bf16 a[128:131], a[112:115], v[184:187], a[128:131]
    v_mfma_f32_16x16x32_bf16 a[132:135], a[116:119], v[184:187], a[132:135]
    s_waitcnt vmcnt(9)
    buffer_load_dwordx4 v[228:231], v18, s[36:39], s100 offen offset:1024 sc1
    v_mfma_f32_16x16x32_bf16 a[152:155], a[120:123], v[188:191], a[152:155]
    v_mfma_f32_16x16x32_bf16 a[156:159], a[124:127], v[188:191], a[156:159]
    v_mfma_f32_16x16x32_bf16 a[136:139], a[112:115], v[188:191], a[136:139]
    v_mfma_f32_16x16x32_bf16 a[140:143], a[116:119], v[188:191], a[140:143]
    s_waitcnt vmcnt(9)
    buffer_load_dwordx4 v[232:235], v18, s[36:39], s100 offen offset:2048 sc1
    v_mfma_f32_16x16x32_bf16 a[160:163], a[8:11], v[192:195], 0
    v_mfma_f32_16x16x32_bf16 a[164:167], a[12:15], v[192:195], 0
    s_waitcnt vmcnt(9)
    buffer_load_dwordx4 v[236:239], v18, s[36:39], s100 offen offset:3072 sc1
    v_mfma_f32_16x16x32_bf16 a[168:171], a[8:11], v[196:199], 0
    v_mfma_f32_16x16x32_bf16 a[172:175], a[12:15], v[196:199], 0
    ds_write_b128 v20, a[144:147] offset:0
    s_waitcnt vmcnt(9)
    buffer_load_dwordx4 v[240:243], v18, s[36:39], s101 offen offset:0 sc1
    v_mfma_f32_16x16x32_bf16 a[160:163], a[24:27], v[200:203], a[160:163]
    v_mfma_f32_16x16x32_bf16 a[164:167], a[28:31], v[200:203], a[164:167]
    s_waitcnt vmcnt(9)
    buffer_load_dwordx4 v[244:247], v18, s[36:39], s101 offen offset:1024 sc1
    v_mfma_f32_16x16x32_bf16 a[168:171], a[24:27], v[204:207], a[168:171]
    v_mfma_f32_16x16x32_bf16 a[172:175], a[28:31], v[204:207], a[172:175]
    ds_write_b128 v20, a[148:151] offset:1024
    s_waitcnt vmcnt(9)
    buffer_load_dwordx4 v[248:251], v18, s[36:39], s101 offen offset:2048 sc1
    v_mfma_f32_16x16x32_bf16 a[160:163], a[40:43], v[208:211], a[160:163]
    v_mfma_f32_16x16x32_bf16 a[164:167], a[44:47], v[208:211], a[164:167]
    v_mfma_f32_16x16x32_bf16 v[32:35], a[0:3], v[192:195], v[80:83]
    v_mfma_f32_16x16x32_bf16 v[36:39], a[4:7], v[192:195], v[84:87]
    ds_write_b128 v20, a[152:155] offset:2048
    s_waitcnt vmcnt(9)
    buffer_load_dwordx4 v[252:255], v18, s[36:39], s101 offen offset:3072 sc1
    v_mfma_f32_16x16x32_bf16 a[168:171], a[40:43], v[212:215], a[168:171]
    v_mfma_f32_16x16x32_bf16 a[172:175], a[44:47], v[212:215], a[172:175]
    v_mfma_f32_16x16x32_bf16 v[40:43], a[0:3], v[196:199], v[80:83]
    v_mfma_f32_16x16x32_bf16 v[44:47], a[4:7], v[196:199], v[84:87]
    ds_write_b128 v20, a[156:159] offset:3072
    s_waitcnt vmcnt(9)
    v_mfma_f32_16x16x32_bf16 a[160:163], a[56:59], v[216:219], a[160:163]
    v_mfma_f32_16x16x32_bf16 a[164:167], a[60:63], v[216:219], a[164:167]
    v_mfma_f32_16x16x32_bf16 v[32:35], a[16:19], v[200:203], v[32:35]
    v_mfma_f32_16x16x32_bf16 v[36:39], a[20:23], v[200:203], v[36:39]
    ds_write_b128 v19, a[128:131] offset:0
    s_waitcnt vmcnt(8)
    v_mfma_f32_16x16x32_bf16 a[168:171], a[56:59], v[220:223], a[168:171]
    v_mfma_f32_16x16x32_bf16 a[172:175], a[60:63], v[220:223], a[172:175]
    v_mfma_f32_16x16x32_bf16 v[40:43], a[16:19], v[204:207], v[40:43]
    v_mfma_f32_16x16x32_bf16 v[44:47], a[20:23], v[204:207], v[44:47]
    ds_write_b128 v19, a[132:135] offset:1024
    s_waitcnt vmcnt(7)
    v_mfma_f32_16x16x32_bf16 a[160:163], a[72:75], v[224:227], a[160:163]
    v_mfma_f32_16x16x32_bf16 a[164:167], a[76:79], v[224:227], a[164:167]
    v_mfma_f32_16x16x32_bf16 v[32:35], a[32:35], v[208:211], v[32:35]
    v_mfma_f32_16x16x32_bf16 v[36:39], a[36:39], v[208:211], v[36:39]
    ds_write_b128 v19, a[136:139] offset:2048
    s_waitcnt vmcnt(6)
    v_mfma_f32_16x16x32_bf16 a[168:171], a[72:75], v[228:231], a[168:171]
    v_mfma_f32_16x16x32_bf16 a[172:175], a[76:79], v[228:231], a[172:175]
    v_mfma_f32_16x16x32_bf16 v[40:43], a[32:35], v[212:215], v[40:43]
    v_mfma_f32_16x16x32_bf16 v[44:47], a[36:39], v[212:215], v[44:47]
    ds_write_b128 v19, a[140:143] offset:3072
    s_waitcnt vmcnt(5)
    v_mfma_f32_16x16x32_bf16 a[160:163], a[88:91], v[232:235], a[160:163]
    v_mfma_f32_16x16x32_bf16 a[164:167], a[92:95], v[232:235], a[164:167]
    v_mfma_f32_16x16x32_bf16 v[32:35], a[48:51], v[216:219], v[32:35]
    v_mfma_f32_16x16x32_bf16 v[36:39], a[52:55], v[216:219], v[36:39]
    s_waitcnt vmcnt(4)
    v_mfma_f32_16x16x32_bf16 a[168:171], a[88:91], v[236:239], a[168:171]
    v_mfma_f32_16x16x32_bf16 a[172:175], a[92:95], v[236:239], a[172:175]
    v_mfma_f32_16x16x32_bf16 v[40:43], a[48:51], v[220:223], v[40:43]
    v_mfma_f32_16x16x32_bf16 v[44:47], a[52:55], v[220:223], v[44:47]
    s_waitcnt vmcnt(3)
    s_waitcnt lgkmcnt(0)
    s_barrier
    ds_read_b128 v[128:131], v22 offset:32768
    ds_read_b128 v[132:135], v22 offset:33792
    ds_read_b128 v[136:139], v22 offset:34816
    ds_read_b128 v[140:143], v22 offset:35840
    ds_read_b128 v[144:147], v22 offset:36864
    ds_read_b128 v[148:151], v22 offset:37888
    ds_read_b128 v[152:155], v22 offset:38912
    ds_read_b128 v[156:159], v22 offset:39936
    s_or_b32 s51, s50, s40
    s_cbranch_scc1 L_ep
    s_lshl_b32 s51, s49, 8
    s_add_u32 s51, s51, 0x4a0000
    s_atomic_swap_x2 s[4:5], s[36:37], s51
L_ep:
    v_mfma_f32_16x16x32_bf16 a[160:163], a[104:107], v[240:243], a[160:163]
    v_mfma_f32_16x16x32_bf16 a[164:167], a[108:111], v[240:243], a[164:167]
    v_mfma_f32_16x16x32_bf16 v[32:35], a[64:67], v[224:227], v[32:35]
    v_mfma_f32_16x16x32_bf16 v[36:39], a[68:71], v[224:227], v[36:39]
    s_waitcnt vmcnt(2)
    v_mfma_f32_16x16x32_bf16 a[168:171], a[104:107], v[244:247], a[168:171]
    v_mfma_f32_16x16x32_bf16 a[172:175], a[108:111], v[244:247], a[172:175]
    v_mfma_f32_16x16x32_bf16 v[40:43], a[64:67], v[228:231], v[40:43]
    v_mfma_f32_16x16x32_bf16 v[44:47], a[68:71], v[228:231], v[44:47]
    s_waitcnt vmcnt(1)
    s_waitcnt lgkmcnt(0)
    v_mfma_f32_16x16x32_bf16 a[160:163], a[120:123], v[248:251], a[160:163]
    v_add_f32 v128, v128, v144
    v_add_f32 v129, v129, v145
    v_mfma_f32_16x16x32_bf16 a[164:167], a[124:127], v[248:251], a[164:167]
    v_add_f32 v130, v130, v146
    v_add_f32 v131, v131, v147
    v_mfma_f32_16x16x32_bf16 v[32:35], a[80:83], v[232:235], v[32:35]
    v_add_f32 v132, v132, v148
    v_add_f32 v133, v133, v149
    v_mfma_f32_16x16x32_bf16 v[36:39], a[84:87], v[232:235], v[36:39]
    v_add_f32 v134, v134, v150
    v_add_f32 v135, v135, v151
    s_waitcnt vmcnt(0)
    v_mfma_f32_16x16x32_bf16 a[168:171], a[120:123], v[252:255], a[168:171]
    v_add_f32 v136, v136, v152
    v_add_f32 v137, v137, v153
    v_mfma_f32_16x16x32_bf16 a[172:175], a[124:127], v[252:255], a[172:175]
    v_add_f32 v138, v138, v154
    v_add_f32 v139, v139, v155
    v_mfma_f32_16x16x32_bf16 v[40:43], a[80:83], v[236:239], v[40:43]
    v_add_f32 v140, v140, v156
    v_add_f32 v141, v141, v157
    v_mfma_f32_16x16x32_bf16 v[44:47], a[84:87], v[236:239], v[44:47]
    v_add_f32 v142, v142, v158
    v_add_f32 v143, v143, v159
    ds_write_b128 v21, a[160:163] offset:0
    v_mfma_f32_16x16x32_bf16 v[32:35], a[96:99], v[240:243], v[32:35]
    v_fmac_f32 v64, v48, v128
    v_fmac_f32 v65, v49, v129
    v_mfma_f32_16x16x32_bf16 v[36:39], a[100:103], v[240:243], v[36:39]
    v_fmac_f32 v66, v50, v130
    v_fmac_f32 v67, v51, v131
    ds_write_b128 v21, a[164:167] offset:1024
    v_mfma_f32_16x16x32_bf16 v[40:43], a[96:99], v[244:247], v[40:43]
    v_fmac_f32 v68, v52, v132
    v_fmac_f32 v69, v53, v133
    v_mfma_f32_16x16x32_bf16 v[44:47], a[100:103], v[244:247], v[44:47]
    v_fmac_f32 v70, v54, v134
    v_fmac_f32 v71, v55, v135
    ds_write_b128 v21, a[168:171] offset:2048
    v_mfma_f32_16x16x32_bf16 v[32:35], a[112:115], v[248:251], v[32:35]
    v_fmac_f32 v72, v56, v136
    v_fmac_f32 v73, v57, v137
    v_mfma_f32_16x16x32_bf16 v[36:39], a[116:119], v[248:251], v[36:39]
    v_fmac_f32 v74, v58, v138
    v_fmac_f32 v75, v59, v139
    ds_write_b128 v21, a[172:175] offset:3072
    v_mfma_f32_16x16x32_bf16 v[40:43], a[112:115], v[252:255], v[40:43]
    v_fmac_f32 v76, v60, v140
    v_fmac_f32 v77, v61, v141
    v_mfma_f32_16x16x32_bf16 v[44:47], a[116:119], v[252:255], v[44:47]
    v_fmac_f32 v78, v62, v142
    v_fmac_f32 v79, v63, v143
    s_waitcnt lgkmcnt(0)
    s_barrier
    ds_read_b128 v[160:163], v22 offset:28672
    ds_read_b128 v[164:167], v22 offset:29696
    ds_read_b128 v[168:171], v22 offset:30720
    ds_read_b128 v[172:175], v22 offset:31744
    v_fmac_f32 v64, v48, v32
    v_fmac_f32 v65, v49, v33
    v_fmac_f32 v66, v50, v34
    v_fmac_f32 v67, v51, v35
    v_fmac_f32 v68, v52, v36
    v_fmac_f32 v69, v53, v37
    v_fmac_f32 v70, v54, v38
    v_fmac_f32 v71, v55, v39
    v_fmac_f32 v72, v56, v40
    v_fmac_f32 v73, v57, v41
    v_fmac_f32 v74, v58, v42
    v_fmac_f32 v75, v59, v43
    v_fmac_f32 v76, v60, v44
    v_fmac_f32 v77, v61, v45
    v_fmac_f32 v78, v62, v46
    v_fmac_f32 v79, v63, v47
    s_waitcnt lgkmcnt(2)
    v_fmac_f32 v64, v48, v160
    v_fmac_f32 v65, v49, v161
    v_fmac_f32 v66, v50, v162
    v_fmac_f32 v67, v51, v163
    v_fmac_f32 v68, v52, v164
    v_fmac_f32 v69, v53, v165
    v_fmac_f32 v70, v54, v166
    v_fmac_f32 v71, v55, v167
    v_cvt_pk_bf16_f32 v120, v64, v65
    v_cvt_pk_bf16_f32 v121, v66, v67
    v_cvt_pk_bf16_f32 v122, v68, v69
    v_cvt_pk_bf16_f32 v123, v70, v71
    buffer_store_dwordx4 v[120:123], v24, s[28:31], 0 offen sc1
    s_waitcnt lgkmcnt(0)
    v_fmac_f32 v72, v56, v168
    v_fmac_f32 v73, v57, v169
    v_fmac_f32 v74, v58, v170
    v_fmac_f32 v75, v59, v171
    v_fmac_f32 v76, v60, v172
    v_fmac_f32 v77, v61, v173
    v_fmac_f32 v78, v62, v174
    v_fmac_f32 v79, v63, v175
    v_cvt_pk_bf16_f32 v124, v72, v73
    v_cvt_pk_bf16_f32 v125, v74, v75
    v_cvt_pk_bf16_f32 v126, v76, v77
    v_cvt_pk_bf16_f32 v127, v78, v79
    buffer_store_dwordx4 v[124:127], v24, s[28:31], s58 offen sc1
L_end:
    s_endpgm
.section .rodata,"a"
.p2align 6
.amdhsa_kernel standalone__dcn_v2_cross__recsys_kernel
  .amdhsa_next_free_vgpr 432
  .amdhsa_next_free_sgpr 102
  .amdhsa_accum_offset 256
  .amdhsa_group_segment_fixed_size 0
  .amdhsa_kernarg_size 48
  .amdhsa_user_sgpr_count 2
  .amdhsa_user_sgpr_kernarg_segment_ptr 1
  .amdhsa_system_sgpr_workgroup_id_x 1
.end_amdhsa_kernel
```
